```python
import torch

def _softmax(x, axis=-1):
    return torch.softmax(x, dim=axis)
def _gelu(x):
    return torch.nn.functional.gelu(x, approximate="tanh")
def _silu(x):
    return torch.nn.functional.silu(x)
def _sigmoid(x):
    return torch.sigmoid(x)
def _layernorm(x, axis=-1, eps=1e-5):
    m = x.mean(dim=axis, keepdim=True)
    v = x.var(dim=axis, keepdim=True, unbiased=False)
    return (x - m) / torch.sqrt(v + eps)
def _scatter_add(tgt, idx, src, axis=0):
    return tgt.clone().index_add_(axis, idx, src)
def _segment_sum(src, seg, n):
    out = torch.zeros((n,) + src.shape[1:], dtype=src.dtype)
    return out.index_add_(0, seg, src)
def _pad(x, pw):
    flat = tuple(v for pair in reversed(pw) for v in pair)
    return torch.nn.functional.pad(x, flat)

kernel_name = 'interleave_layers__spectral_fnet__geglu_ffn__prompt'

def setup_inputs():

    _w = (lambda a: (lambda t: t.to(torch.bfloat16) if t.is_floating_point() else t)(torch.as_tensor(a)))
    def _A_setup():
        B, S, D = 1, 2048, 512
        ns = torch.arange(S)[:, None] * torch.arange(S)[None, :]
        nd = torch.arange(D)[:, None] * torch.arange(D)[None, :]
        Ws_re = torch.cos(-2.0 * torch.pi * ns / S).to(float)
        Ws_im = torch.sin(-2.0 * torch.pi * ns / S).to(float)
        Wd_re = torch.cos(-2.0 * torch.pi * nd / D).to(float)
        Wd_im = torch.sin(-2.0 * torch.pi * nd / D).to(float)
        return {
            "x": _w((lambda *s: torch.randn(*s, dtype=torch.bfloat16) * 0.05)(B, S, D)),
            "dft_seq_re": _w(Ws_re),
            "dft_seq_im": _w(Ws_im),
            "dft_hid_re": _w(Wd_re),
            "dft_hid_im": _w(Wd_im),
        }
    _A_in = _A_setup()

    def _B_setup():
        B, S, D, F = 1, 2048, 512, 1792
        return {
            "x": _w((lambda *s: torch.randn(*s, dtype=torch.bfloat16) * 0.05)(B, S, D)),
            "w_gate": _w((lambda *s: torch.randn(*s, dtype=torch.bfloat16) * 0.4)(D, F)),
            "w_up": _w((lambda *s: torch.randn(*s, dtype=torch.bfloat16) * 0.4)(D, F)),
            "w_down": _w((lambda *s: torch.randn(*s, dtype=torch.bfloat16) * 0.4)(F, D)),
        }
    _B_in = _B_setup()

    return {
        "A_x": _A_in["x"],
        "A_dft_seq_re": _A_in["dft_seq_re"],
        "A_dft_seq_im": _A_in["dft_seq_im"],
        "A_dft_hid_re": _A_in["dft_hid_re"],
        "A_dft_hid_im": _A_in["dft_hid_im"],
        "B_x": _B_in["x"],
        "B_w_gate": _B_in["w_gate"],
        "B_w_up": _B_in["w_up"],
        "B_w_down": _B_in["w_down"],
    }

def reference(A_x, A_dft_seq_re, A_dft_seq_im, A_dft_hid_re, A_dft_hid_im, B_x, B_w_gate, B_w_up, B_w_down):
    def _A_ref(x, dft_seq_re, dft_seq_im, dft_hid_re, dft_hid_im):
        a = torch.einsum("bsd,ed->bse", x, dft_hid_re)
        b = torch.einsum("bsd,ed->bse", x, dft_hid_im)
        y = torch.einsum("ts,bse->bte", dft_seq_re, a) - torch.einsum("ts,bse->bte", dft_seq_im, b)
        return y

    def _B_ref(x, w_gate, w_up, w_down):
        return (_gelu(x @ w_gate) * (x @ w_up)) @ w_down

    x = A_x
    x = x + _A_ref(_layernorm(x, axis=-1), A_dft_seq_re, A_dft_seq_im, A_dft_hid_re, A_dft_hid_im)
    x = x + _B_ref(_layernorm(x, axis=-1), B_w_gate, B_w_up, B_w_down)
    x = x + _A_ref(_layernorm(x, axis=-1), A_dft_seq_re, A_dft_seq_im, A_dft_hid_re, A_dft_hid_im)
    x = x + _B_ref(_layernorm(x, axis=-1), B_w_gate, B_w_up, B_w_down)
    return x
```

```asm
; @launch kernel=r0_kernel grid=(256,1,1) block=(512,1,1) lds=163840
; @launch kernel=c0_kernel grid=(384,1,1) block=(512,1,1) lds=66304
; @launch kernel=g1_kernel grid=(256,1,1) block=(512,1,1) lds=147456
; @launch kernel=g20_kernel grid=(256,1,1) block=(512,1,1) lds=163840
; @launch kernel=r1_kernel grid=(256,1,1) block=(512,1,1) lds=163840
; @launch kernel=c1_kernel grid=(256,1,1) block=(512,1,1) lds=66304
; @launch kernel=g1_kernel grid=(256,1,1) block=(512,1,1) lds=147456
; @launch kernel=g21_kernel grid=(256,1,1) block=(512,1,1) lds=163840
.amdgcn_target "amdgcn-amd-amdhsa--gfx950"
.text
.globl r0_kernel
.p2align 8
.type r0_kernel,@function
r0_kernel:
    s_load_dwordx2 s[4:5], s[0:1], 0
    s_load_dwordx2 s[40:41], s[0:1], 24
    s_load_dwordx2 s[42:43], s[0:1], 32
    s_load_dwordx2 s[44:45], s[0:1], 88
    s_cmp_ge_u32 s2, 256
    s_cbranch_scc1 L_r_done_1
    s_and_b32 s46, s2, 7
    s_lshl_b32 s46, s46, 1
    s_bfe_u32 s47, s2, 0x10003
    s_add_u32 s46, s46, s47
    s_lshr_b32 s47, s2, 4
    v_lshrrev_b32 v1, 6, v0
    v_and_b32 v2, 63, v0
    v_readfirstlane_b32 s48, v1
    v_and_b32 v3, 15, v2
    v_lshrrev_b32 v4, 4, v2
    s_lshl_b32 s49, s48, 4
    v_add_u32 v5, 0, v4
    v_xor_b32 v6, v5, v3
    v_add_u32 v5, s49, v5
    v_lshlrev_b32 v5, 14, v5
    v_lshl_add_u32 v8, v6, 4, v5
    v_add_u32 v5, 4, v4
    v_xor_b32 v6, v5, v3
    v_add_u32 v5, s49, v5
    v_lshlrev_b32 v5, 14, v5
    v_lshl_add_u32 v9, v6, 4, v5
    v_add_u32 v5, 8, v4
    v_xor_b32 v6, v5, v3
    v_add_u32 v5, s49, v5
    v_lshlrev_b32 v5, 14, v5
    v_lshl_add_u32 v10, v6, 4, v5
    v_add_u32 v5, 12, v4
    v_xor_b32 v6, v5, v3
    v_add_u32 v5, s49, v5
    v_lshlrev_b32 v5, 14, v5
    v_lshl_add_u32 v11, v6, 4, v5
    s_lshl_b32 s50, s46, 10
    s_and_b32 s51, s48, 3
    s_lshl_b32 s51, s51, 2
    s_lshl_b32 s52, s47, 4
    s_add_u32 s52, s52, s51
    s_lshl_b32 s53, s48, 12
    s_add_u32 s53, s53, 131072
    s_lshl_b32 s54, s48, 14
    s_add_u32 s55, s51, 0
    v_xor_b32 v5, s55, v2
    v_lshlrev_b32 v12, 4, v5
    s_add_u32 s55, s51, 1
    v_xor_b32 v5, s55, v2
    v_lshlrev_b32 v13, 4, v5
    s_add_u32 s55, s51, 2
    v_xor_b32 v5, s55, v2
    v_lshlrev_b32 v14, 4, v5
    s_add_u32 s55, s51, 3
    v_xor_b32 v5, s55, v2
    v_lshlrev_b32 v15, 4, v5
    s_waitcnt lgkmcnt(0)
    s_mov_b32 s8, s4
    s_mov_b32 s9, s5
    s_mov_b32 s10, 2097152
    s_mov_b32 s11, 0x00020000
    s_cmp_ge_u32 s48, 4
    s_cselect_b32 s12, s42, s40
    s_cselect_b32 s13, s43, s41
    s_mov_b32 s14, 0x80000
    s_mov_b32 s15, 0x00020000
    s_add_u32 s55, s52, 0
    s_cmp_eq_u32 s55, 0
    s_cselect_b32 s55, 256, s55
    s_lshl_b32 s55, s55, 10
    s_add_u32 m0, s53, 0
    s_nop 0
    buffer_load_dwordx4 v12, s[12:15], s55 offen lds
    s_add_u32 s55, s52, 1
    s_lshl_b32 s55, s55, 10
    s_add_u32 m0, s53, 1024
    s_nop 0
    buffer_load_dwordx4 v13, s[12:15], s55 offen lds
    s_add_u32 s55, s52, 2
    s_lshl_b32 s55, s55, 10
    s_add_u32 m0, s53, 2048
    s_nop 0
    buffer_load_dwordx4 v14, s[12:15], s55 offen lds
    s_add_u32 s55, s52, 3
    s_lshl_b32 s55, s55, 10
    s_add_u32 m0, s53, 3072
    s_nop 0
    buffer_load_dwordx4 v15, s[12:15], s55 offen lds
    s_add_u32 s60, s48, s47
    s_and_b32 s59, s60, 3
    s_add_u32 s60, s59, 0
    s_and_b32 s60, s60, 3
    s_lshl_b32 s60, s60, 8
    s_add_u32 s61, s59, 1
    s_and_b32 s61, s61, 3
    s_lshl_b32 s61, s61, 8
    s_add_u32 s62, s59, 2
    s_and_b32 s62, s62, 3
    s_lshl_b32 s62, s62, 8
    s_add_u32 s63, s59, 3
    s_and_b32 s63, s63, 3
    s_lshl_b32 s63, s63, 8
    s_sub_u32 s33, s61, s60
    s_sub_u32 s34, s62, s61
    s_sub_u32 s35, s63, s62
    s_mov_b32 s36, s60
    s_add_u32 s60, s60, s50
    s_add_u32 s61, s61, s50
    s_add_u32 s62, s62, s50
    s_add_u32 s63, s63, s50
    s_add_u32 m0, s54, 0
    s_nop 0
    buffer_load_dwordx4 v8, s[8:11], s60 offen lds
    s_add_u32 m0, s54, 1024
    s_nop 0
    buffer_load_dwordx4 v9, s[8:11], s60 offen lds
    s_add_u32 m0, s54, 2048
    s_nop 0
    buffer_load_dwordx4 v10, s[8:11], s60 offen lds
    s_add_u32 m0, s54, 3072
    s_nop 0
    buffer_load_dwordx4 v11, s[8:11], s60 offen lds
    s_add_u32 m0, s54, 4096
    s_nop 0
    buffer_load_dwordx4 v8, s[8:11], s61 offen lds
    s_mov_b32 s28, s44
    s_mov_b32 s29, s45
    s_mov_b32 s30, 2097152
    s_mov_b32 s31, 0x00020000
    v_add_u32 v6, s49, v3
    v_cvt_f32_u32 v5, v6
    v_mul_f32 v5, 0x3c000000, v5
    s_add_u32 m0, s54, 5120
    s_nop 0
    buffer_load_dwordx4 v9, s[8:11], s61 offen lds
    v_lshlrev_b32 v7, 3, v4
    v_cvt_f32_u32 v7, v7
    v_mul_f32 v48, v7, v5
    v_add_f32 v49, v48, v5
    v_add_f32 v50, v49, v5
    v_add_f32 v51, v50, v5
    v_add_f32 v52, v51, v5
    s_add_u32 m0, s54, 6144
    s_nop 0
    buffer_load_dwordx4 v10, s[8:11], s61 offen lds
    v_add_f32 v53, v52, v5
    v_add_f32 v54, v53, v5
    v_add_f32 v55, v54, v5
    v_cos_f32 v56, v48
    v_cos_f32 v57, v49
    v_cos_f32 v58, v50
    v_cos_f32 v59, v51
    s_add_u32 m0, s54, 7168
    s_nop 0
    buffer_load_dwordx4 v11, s[8:11], s61 offen lds
    v_cos_f32 v60, v52
    v_cos_f32 v61, v53
    v_cos_f32 v62, v54
    v_cos_f32 v63, v55
    v_sin_f32 v48, v48
    v_sin_f32 v49, v49
    v_sin_f32 v50, v50
    s_add_u32 m0, s54, 8192
    s_nop 0
    buffer_load_dwordx4 v8, s[8:11], s62 offen lds
    v_sin_f32 v51, v51
    v_sin_f32 v52, v52
    v_sin_f32 v53, v53
    v_sin_f32 v54, v54
    v_sin_f32 v55, v55
    v_mov_b32 v44, 0x80008000
    v_and_b32 v45, 2, v3
    s_add_u32 m0, s54, 9216
    s_nop 0
    buffer_load_dwordx4 v9, s[8:11], s62 offen lds
    v_cmp_ne_u32 vcc, 0, v45
    v_add_u32 v45, 1, v3
    v_cndmask_b32 v46, 0, v44, vcc
    v_and_b32 v45, 2, v45
    v_cmp_ne_u32 vcc, 0, v45
    v_and_b32 v45, 1, v3
    v_cndmask_b32 v47, 0, v44, vcc
    s_add_u32 m0, s54, 10240
    s_nop 0
    buffer_load_dwordx4 v10, s[8:11], s62 offen lds
    v_cmp_ne_u32 vcc, 0, v45
    s_nop 0
    v_cndmask_b32 v45, 0, v44, vcc
    v_cvt_pk_bf16_f32 v64, v56, v57
    v_cvt_pk_bf16_f32 v80, v48, v49
    v_cvt_pk_bf16_f32 v65, v58, v59
    v_cvt_pk_bf16_f32 v81, v50, v51
    s_add_u32 m0, s54, 11264
    s_nop 0
    buffer_load_dwordx4 v11, s[8:11], s62 offen lds
    v_cvt_pk_bf16_f32 v66, v60, v61
    v_cvt_pk_bf16_f32 v82, v52, v53
    v_cvt_pk_bf16_f32 v67, v62, v63
    v_cvt_pk_bf16_f32 v83, v54, v55
    v_cndmask_b32 v68, v64, v80, vcc
    v_cndmask_b32 v84, v80, v64, vcc
    v_cndmask_b32 v69, v65, v81, vcc
    v_cndmask_b32 v85, v81, v65, vcc
    v_cndmask_b32 v70, v66, v82, vcc
    v_cndmask_b32 v86, v82, v66, vcc
    v_cndmask_b32 v71, v67, v83, vcc
    v_cndmask_b32 v87, v83, v67, vcc
    s_add_u32 m0, s54, 12288
    s_nop 0
    buffer_load_dwordx4 v8, s[8:11], s63 offen lds
    v_xor_b32 v68, v68, v47
    v_xor_b32 v84, v84, v46
    s_add_u32 m0, s54, 13312
    s_nop 0
    buffer_load_dwordx4 v9, s[8:11], s63 offen lds
    v_xor_b32 v69, v69, v47
    v_xor_b32 v85, v85, v46
    v_xor_b32 v70, v70, v47
    v_xor_b32 v86, v86, v46
    v_xor_b32 v71, v71, v47
    v_xor_b32 v87, v87, v46
    v_xor_b32 v72, v64, v45
    s_add_u32 m0, s54, 14336
    s_nop 0
    buffer_load_dwordx4 v10, s[8:11], s63 offen lds
    v_xor_b32 v88, v80, v45
    v_xor_b32 v73, v65, v45
    v_xor_b32 v89, v81, v45
    v_xor_b32 v74, v66, v45
    v_xor_b32 v90, v82, v45
    v_xor_b32 v75, v67, v45
    v_xor_b32 v91, v83, v45
    s_add_u32 m0, s54, 15360
    s_nop 0
    buffer_load_dwordx4 v11, s[8:11], s63 offen lds
    v_xor_b32 v76, v68, v45
    v_xor_b32 v92, v84, v45
    v_xor_b32 v77, v69, v45
    v_xor_b32 v93, v85, v45
    v_xor_b32 v78, v70, v45
    v_xor_b32 v94, v86, v45
    v_xor_b32 v79, v71, v45
    v_xor_b32 v95, v87, v45
    v_lshlrev_b32 v5, 2, v4
    v_add_u32 v5, s49, v5
    v_add_u32 v7, 0, v5
    v_mul_u32_u24 v7, s46, v7
    v_cvt_f32_u32 v7, v7
    v_mul_f32 v7, 0xba000000, v7
    v_cos_f32 v96, v7
    v_sin_f32 v100, v7
    v_add_u32 v7, 1, v5
    v_mul_u32_u24 v7, s46, v7
    v_cvt_f32_u32 v7, v7
    v_mul_f32 v7, 0xba000000, v7
    v_cos_f32 v97, v7
    v_sin_f32 v101, v7
    v_add_u32 v7, 2, v5
    v_mul_u32_u24 v7, s46, v7
    v_cvt_f32_u32 v7, v7
    v_mul_f32 v7, 0xba000000, v7
    v_cos_f32 v98, v7
    v_sin_f32 v102, v7
    v_add_u32 v7, 3, v5
    v_mul_u32_u24 v7, s46, v7
    v_cvt_f32_u32 v7, v7
    v_mul_f32 v7, 0xba000000, v7
    v_cos_f32 v99, v7
    v_sin_f32 v103, v7
    v_lshlrev_b32 v7, 14, v5
    v_lshl_add_u32 v104, v3, 2, v7
    s_lshl_b32 s56, s46, 10
    s_lshl_b32 s57, s47, 6
    s_add_u32 s56, s56, s57
    v_lshrrev_b32 v5, 3, v3
    v_lshlrev_b32 v5, 7, v5
    v_lshl_add_u32 v5, v3, 5, v5
    v_lshl_add_u32 v5, v4, 3, v5
    v_add_u32 v105, s54, v5
    v_lshrrev_b32 v5, 1, v4
    v_lshlrev_b32 v5, 14, v5
    v_and_b32 v6, 1, v4
    v_mul_u32_u24 v6, 384, v6
    v_add_u32 v5, v5, v6
    v_lshrrev_b32 v6, 2, v3
    v_lshl_add_u32 v5, v6, 5, v5
    v_and_b32 v6, 3, v3
    v_lshl_add_u32 v106, v6, 3, v5
    v_add_u32 v107, 65536, v106
    v_add_u32 v5, 0, v4
    v_xor_b32 v5, v5, v3
    v_lshlrev_b32 v5, 4, v5
    v_lshl_add_u32 v16, v3, 8, v5
    v_add_u32 v16, s54, v16
    v_lshl_add_u32 v20, v3, 10, v5
    v_add_u32 v20, 131072, v20
    v_add_u32 v20, s36, v20
    v_add_u32 v5, 4, v4
    v_xor_b32 v5, v5, v3
    v_lshlrev_b32 v5, 4, v5
    v_lshl_add_u32 v17, v3, 8, v5
    v_add_u32 v17, s54, v17
    v_lshl_add_u32 v21, v3, 10, v5
    v_add_u32 v21, 131072, v21
    v_add_u32 v21, s36, v21
    v_add_u32 v5, 8, v4
    v_xor_b32 v5, v5, v3
    v_lshlrev_b32 v5, 4, v5
    v_lshl_add_u32 v18, v3, 8, v5
    v_add_u32 v18, s54, v18
    v_lshl_add_u32 v22, v3, 10, v5
    v_add_u32 v22, 131072, v22
    v_add_u32 v22, s36, v22
    v_add_u32 v5, 12, v4
    v_xor_b32 v5, v5, v3
    v_lshlrev_b32 v5, 4, v5
    v_lshl_add_u32 v19, v3, 8, v5
    v_add_u32 v19, s54, v19
    v_lshl_add_u32 v23, v3, 10, v5
    v_add_u32 v23, 131072, v23
    v_add_u32 v23, s36, v23
    v_mov_b32 v24, 0x3f803f80
    v_mov_b32 v25, 0x3f803f80
    v_mov_b32 v26, 0x3f803f80
    v_mov_b32 v27, 0x3f803f80
    v_mov_b32 v14, 0
    v_mov_b32 v15, 0
    s_waitcnt vmcnt(12)
    s_barrier
    ds_read_b128 v[116:119], v16 offset:0
    ds_read_b128 v[108:111], v20 offset:0
    ds_read_b128 v[112:115], v20 offset:16384
    ds_read_b128 v[128:131], v17 offset:0
    ds_read_b128 v[120:123], v21 offset:0
    ds_read_b128 v[124:127], v21 offset:16384
    ds_read_b128 v[140:143], v18 offset:0
    ds_read_b128 v[132:135], v22 offset:0
    ds_read_b128 v[136:139], v22 offset:16384
    ds_read_b128 v[152:155], v19 offset:0
    ds_read_b128 v[144:147], v23 offset:0
    ds_read_b128 v[148:151], v23 offset:16384
    v_add_u32 v20, s33, v20
    v_add_u32 v21, s33, v21
    v_add_u32 v22, s33, v22
    v_add_u32 v23, s33, v23
    s_waitcnt lgkmcnt(9)
    v_mfma_f32_16x16x32_bf16 v[28:31], v[108:111], v[116:119], 0
    v_dot2_f32_bf16 v14, v116, v116, v14
    v_dot2_f32_bf16 v15, v117, v117, v15
    v_mfma_f32_16x16x32_bf16 v[32:35], v[112:115], v[116:119], 0
    v_dot2_f32_bf16 v14, v118, v118, v14
    v_dot2_f32_bf16 v15, v119, v119, v15
    v_mfma_f32_16x16x32_bf16 v[36:39], v[24:27], v[116:119], 0
    s_waitcnt lgkmcnt(6)
    v_mfma_f32_16x16x32_bf16 v[28:31], v[120:123], v[128:131], v[28:31]
    v_dot2_f32_bf16 v14, v128, v128, v14
    v_dot2_f32_bf16 v15, v129, v129, v15
    v_mfma_f32_16x16x32_bf16 v[32:35], v[124:127], v[128:131], v[32:35]
    v_dot2_f32_bf16 v14, v130, v130, v14
    v_dot2_f32_bf16 v15, v131, v131, v15
    v_mfma_f32_16x16x32_bf16 v[36:39], v[24:27], v[128:131], v[36:39]
    s_waitcnt lgkmcnt(3)
    v_mfma_f32_16x16x32_bf16 v[28:31], v[132:135], v[140:143], v[28:31]
    v_dot2_f32_bf16 v14, v140, v140, v14
    v_dot2_f32_bf16 v15, v141, v141, v15
    v_mfma_f32_16x16x32_bf16 v[32:35], v[136:139], v[140:143], v[32:35]
    v_dot2_f32_bf16 v14, v142, v142, v14
    v_dot2_f32_bf16 v15, v143, v143, v15
    v_mfma_f32_16x16x32_bf16 v[36:39], v[24:27], v[140:143], v[36:39]
    s_waitcnt lgkmcnt(0)
    v_mfma_f32_16x16x32_bf16 v[28:31], v[144:147], v[152:155], v[28:31]
    v_dot2_f32_bf16 v14, v152, v152, v14
    v_dot2_f32_bf16 v15, v153, v153, v15
    v_mfma_f32_16x16x32_bf16 v[32:35], v[148:151], v[152:155], v[32:35]
    v_dot2_f32_bf16 v14, v154, v154, v14
    v_dot2_f32_bf16 v15, v155, v155, v15
    v_mfma_f32_16x16x32_bf16 v[36:39], v[24:27], v[152:155], v[36:39]
    s_waitcnt vmcnt(8)
    ds_read_b128 v[116:119], v16 offset:4096
    ds_read_b128 v[108:111], v20 offset:0
    ds_read_b128 v[112:115], v20 offset:16384
    ds_read_b128 v[128:131], v17 offset:4096
    ds_read_b128 v[120:123], v21 offset:0
    ds_read_b128 v[124:127], v21 offset:16384
    ds_read_b128 v[140:143], v18 offset:4096
    ds_read_b128 v[132:135], v22 offset:0
    ds_read_b128 v[136:139], v22 offset:16384
    ds_read_b128 v[152:155], v19 offset:4096
    ds_read_b128 v[144:147], v23 offset:0
    ds_read_b128 v[148:151], v23 offset:16384
    v_add_u32 v20, s34, v20
    v_add_u32 v21, s34, v21
    v_add_u32 v22, s34, v22
    v_add_u32 v23, s34, v23
    s_waitcnt lgkmcnt(9)
    v_mfma_f32_16x16x32_bf16 v[28:31], v[108:111], v[116:119], v[28:31]
    v_dot2_f32_bf16 v14, v116, v116, v14
    v_dot2_f32_bf16 v15, v117, v117, v15
    v_mfma_f32_16x16x32_bf16 v[32:35], v[112:115], v[116:119], v[32:35]
    v_dot2_f32_bf16 v14, v118, v118, v14
    v_dot2_f32_bf16 v15, v119, v119, v15
    v_mfma_f32_16x16x32_bf16 v[36:39], v[24:27], v[116:119], v[36:39]
    s_waitcnt lgkmcnt(6)
    v_mfma_f32_16x16x32_bf16 v[28:31], v[120:123], v[128:131], v[28:31]
    v_dot2_f32_bf16 v14, v128, v128, v14
    v_dot2_f32_bf16 v15, v129, v129, v15
    v_mfma_f32_16x16x32_bf16 v[32:35], v[124:127], v[128:131], v[32:35]
    v_dot2_f32_bf16 v14, v130, v130, v14
    v_dot2_f32_bf16 v15, v131, v131, v15
    v_mfma_f32_16x16x32_bf16 v[36:39], v[24:27], v[128:131], v[36:39]
    s_waitcnt lgkmcnt(3)
    v_mfma_f32_16x16x32_bf16 v[28:31], v[132:135], v[140:143], v[28:31]
    v_dot2_f32_bf16 v14, v140, v140, v14
    v_dot2_f32_bf16 v15, v141, v141, v15
    v_mfma_f32_16x16x32_bf16 v[32:35], v[136:139], v[140:143], v[32:35]
    v_dot2_f32_bf16 v14, v142, v142, v14
    v_dot2_f32_bf16 v15, v143, v143, v15
    v_mfma_f32_16x16x32_bf16 v[36:39], v[24:27], v[140:143], v[36:39]
    s_waitcnt lgkmcnt(0)
    v_mfma_f32_16x16x32_bf16 v[28:31], v[144:147], v[152:155], v[28:31]
    v_dot2_f32_bf16 v14, v152, v152, v14
    v_dot2_f32_bf16 v15, v153, v153, v15
    v_mfma_f32_16x16x32_bf16 v[32:35], v[148:151], v[152:155], v[32:35]
    v_dot2_f32_bf16 v14, v154, v154, v14
    v_dot2_f32_bf16 v15, v155, v155, v15
    v_mfma_f32_16x16x32_bf16 v[36:39], v[24:27], v[152:155], v[36:39]
    s_waitcnt vmcnt(4)
    ds_read_b128 v[116:119], v16 offset:8192
    ds_read_b128 v[108:111], v20 offset:0
    ds_read_b128 v[112:115], v20 offset:16384
    ds_read_b128 v[128:131], v17 offset:8192
    ds_read_b128 v[120:123], v21 offset:0
    ds_read_b128 v[124:127], v21 offset:16384
    ds_read_b128 v[140:143], v18 offset:8192
    ds_read_b128 v[132:135], v22 offset:0
    ds_read_b128 v[136:139], v22 offset:16384
    ds_read_b128 v[152:155], v19 offset:8192
    ds_read_b128 v[144:147], v23 offset:0
    ds_read_b128 v[148:151], v23 offset:16384
    v_add_u32 v20, s35, v20
    v_add_u32 v21, s35, v21
    v_add_u32 v22, s35, v22
    v_add_u32 v23, s35, v23
    s_waitcnt lgkmcnt(9)
    v_mfma_f32_16x16x32_bf16 v[28:31], v[108:111], v[116:119], v[28:31]
    v_dot2_f32_bf16 v14, v116, v116, v14
    v_dot2_f32_bf16 v15, v117, v117, v15
    v_mfma_f32_16x16x32_bf16 v[32:35], v[112:115], v[116:119], v[32:35]
    v_dot2_f32_bf16 v14, v118, v118, v14
    v_dot2_f32_bf16 v15, v119, v119, v15
    v_mfma_f32_16x16x32_bf16 v[36:39], v[24:27], v[116:119], v[36:39]
    s_waitcnt lgkmcnt(6)
    v_mfma_f32_16x16x32_bf16 v[28:31], v[120:123], v[128:131], v[28:31]
    v_dot2_f32_bf16 v14, v128, v128, v14
    v_dot2_f32_bf16 v15, v129, v129, v15
    v_mfma_f32_16x16x32_bf16 v[32:35], v[124:127], v[128:131], v[32:35]
    v_dot2_f32_bf16 v14, v130, v130, v14
    v_dot2_f32_bf16 v15, v131, v131, v15
    v_mfma_f32_16x16x32_bf16 v[36:39], v[24:27], v[128:131], v[36:39]
    s_waitcnt lgkmcnt(3)
    v_mfma_f32_16x16x32_bf16 v[28:31], v[132:135], v[140:143], v[28:31]
    v_dot2_f32_bf16 v14, v140, v140, v14
    v_dot2_f32_bf16 v15, v141, v141, v15
    v_mfma_f32_16x16x32_bf16 v[32:35], v[136:139], v[140:143], v[32:35]
    v_dot2_f32_bf16 v14, v142, v142, v14
    v_dot2_f32_bf16 v15, v143, v143, v15
    v_mfma_f32_16x16x32_bf16 v[36:39], v[24:27], v[140:143], v[36:39]
    s_waitcnt lgkmcnt(0)
    v_mfma_f32_16x16x32_bf16 v[28:31], v[144:147], v[152:155], v[28:31]
    v_dot2_f32_bf16 v14, v152, v152, v14
    v_dot2_f32_bf16 v15, v153, v153, v15
    v_mfma_f32_16x16x32_bf16 v[32:35], v[148:151], v[152:155], v[32:35]
    v_dot2_f32_bf16 v14, v154, v154, v14
    v_dot2_f32_bf16 v15, v155, v155, v15
    v_mfma_f32_16x16x32_bf16 v[36:39], v[24:27], v[152:155], v[36:39]
    s_waitcnt vmcnt(0)
    ds_read_b128 v[116:119], v16 offset:12288
    ds_read_b128 v[108:111], v20 offset:0
    ds_read_b128 v[112:115], v20 offset:16384
    ds_read_b128 v[128:131], v17 offset:12288
    ds_read_b128 v[120:123], v21 offset:0
    ds_read_b128 v[124:127], v21 offset:16384
    ds_read_b128 v[140:143], v18 offset:12288
    ds_read_b128 v[132:135], v22 offset:0
    ds_read_b128 v[136:139], v22 offset:16384
    ds_read_b128 v[152:155], v19 offset:12288
    ds_read_b128 v[144:147], v23 offset:0
    ds_read_b128 v[148:151], v23 offset:16384
    s_waitcnt lgkmcnt(9)
    v_mfma_f32_16x16x32_bf16 v[28:31], v[108:111], v[116:119], v[28:31]
    v_dot2_f32_bf16 v14, v116, v116, v14
    v_dot2_f32_bf16 v15, v117, v117, v15
    v_mfma_f32_16x16x32_bf16 v[32:35], v[112:115], v[116:119], v[32:35]
    v_dot2_f32_bf16 v14, v118, v118, v14
    v_dot2_f32_bf16 v15, v119, v119, v15
    v_mfma_f32_16x16x32_bf16 v[36:39], v[24:27], v[116:119], v[36:39]
    s_waitcnt lgkmcnt(6)
    v_mfma_f32_16x16x32_bf16 v[28:31], v[120:123], v[128:131], v[28:31]
    v_dot2_f32_bf16 v14, v128, v128, v14
    v_dot2_f32_bf16 v15, v129, v129, v15
    v_mfma_f32_16x16x32_bf16 v[32:35], v[124:127], v[128:131], v[32:35]
    v_dot2_f32_bf16 v14, v130, v130, v14
    v_dot2_f32_bf16 v15, v131, v131, v15
    v_mfma_f32_16x16x32_bf16 v[36:39], v[24:27], v[128:131], v[36:39]
    s_waitcnt lgkmcnt(3)
    v_mfma_f32_16x16x32_bf16 v[28:31], v[132:135], v[140:143], v[28:31]
    v_dot2_f32_bf16 v14, v140, v140, v14
    v_dot2_f32_bf16 v15, v141, v141, v15
    v_mfma_f32_16x16x32_bf16 v[32:35], v[136:139], v[140:143], v[32:35]
    v_dot2_f32_bf16 v14, v142, v142, v14
    v_dot2_f32_bf16 v15, v143, v143, v15
    v_mfma_f32_16x16x32_bf16 v[36:39], v[24:27], v[140:143], v[36:39]
    s_waitcnt lgkmcnt(0)
    v_mfma_f32_16x16x32_bf16 v[28:31], v[144:147], v[152:155], v[28:31]
    v_dot2_f32_bf16 v14, v152, v152, v14
    v_dot2_f32_bf16 v15, v153, v153, v15
    v_mfma_f32_16x16x32_bf16 v[32:35], v[148:151], v[152:155], v[32:35]
    v_dot2_f32_bf16 v14, v154, v154, v14
    v_dot2_f32_bf16 v15, v155, v155, v15
    v_mfma_f32_16x16x32_bf16 v[36:39], v[24:27], v[152:155], v[36:39]
    s_nop 3
    v_add_f32 v14, v14, v15
    s_nop 1
    v_mov_b32 v15, v14
    s_nop 1
    v_permlane32_swap_b32 v14, v15
    s_nop 1
    v_add_f32 v14, v14, v15
    s_nop 1
    v_mov_b32 v15, v14
    s_nop 1
    v_permlane16_swap_b32 v14, v15
    s_nop 1
    v_add_f32 v14, v14, v15
    v_mul_f32 v15, 0x3b000000, v36
    v_mul_f32 v14, 0x3b000000, v14
    v_fma_f32 v14, -v15, v15, v14
    v_add_f32 v14, 0x3727c5ac, v14
    v_rsq_f32 v14, v14
    s_nop 0
    v_mul_f32 v28, v28, v14
    v_mul_f32 v29, v29, v14
    v_mul_f32 v30, v30, v14
    v_mul_f32 v31, v31, v14
    v_mul_f32 v32, v32, v14
    v_mul_f32 v33, v33, v14
    v_mul_f32 v34, v34, v14
    v_mul_f32 v35, v35, v14
    v_cvt_pk_bf16_f32 v40, v28, v29
    v_cvt_pk_bf16_f32 v41, v30, v31
    v_cvt_pk_bf16_f32 v42, v32, v33
    v_cvt_pk_bf16_f32 v43, v34, v35
    ds_write_b64 v105, v[40:41]
    ds_write_b64 v105, v[42:43] offset:1024
    s_waitcnt lgkmcnt(0)
    s_barrier
    ds_read_b64_tr_b16 v[108:109], v106 offset:0
    ds_read_b64_tr_b16 v[110:111], v106 offset:128
    ds_read_b64_tr_b16 v[124:125], v106 offset:1024
    ds_read_b64_tr_b16 v[126:127], v106 offset:1152
    ds_read_b64_tr_b16 v[112:113], v106 offset:32768
    ds_read_b64_tr_b16 v[114:115], v106 offset:32896
    ds_read_b64_tr_b16 v[128:129], v106 offset:33792
    ds_read_b64_tr_b16 v[130:131], v106 offset:33920
    ds_read_b64_tr_b16 v[116:117], v107 offset:0
    ds_read_b64_tr_b16 v[118:119], v107 offset:128
    ds_read_b64_tr_b16 v[132:133], v107 offset:1024
    ds_read_b64_tr_b16 v[134:135], v107 offset:1152
    ds_read_b64_tr_b16 v[120:121], v107 offset:32768
    ds_read_b64_tr_b16 v[122:123], v107 offset:32896
    ds_read_b64_tr_b16 v[136:137], v107 offset:33792
    ds_read_b64_tr_b16 v[138:139], v107 offset:33920
    s_waitcnt lgkmcnt(12)
    v_mfma_f32_16x16x32_bf16 v[28:31], v[64:67], v[108:111], 0
    v_mfma_f32_16x16x32_bf16 v[32:35], v[80:83], v[124:127], 0
    v_mfma_f32_16x16x32_bf16 v[36:39], v[64:67], v[124:127], 0
    v_mfma_f32_16x16x32_bf16 v[44:47], v[80:83], v[108:111], 0
    s_waitcnt lgkmcnt(8)
    v_mfma_f32_16x16x32_bf16 v[28:31], v[68:71], v[112:115], v[28:31]
    v_mfma_f32_16x16x32_bf16 v[32:35], v[84:87], v[128:131], v[32:35]
    v_mfma_f32_16x16x32_bf16 v[36:39], v[68:71], v[128:131], v[36:39]
    v_mfma_f32_16x16x32_bf16 v[44:47], v[84:87], v[112:115], v[44:47]
    s_waitcnt lgkmcnt(4)
    v_mfma_f32_16x16x32_bf16 v[28:31], v[72:75], v[116:119], v[28:31]
    v_mfma_f32_16x16x32_bf16 v[32:35], v[88:91], v[132:135], v[32:35]
    v_mfma_f32_16x16x32_bf16 v[36:39], v[72:75], v[132:135], v[36:39]
    v_mfma_f32_16x16x32_bf16 v[44:47], v[88:91], v[116:119], v[44:47]
    s_waitcnt lgkmcnt(0)
    v_mfma_f32_16x16x32_bf16 v[28:31], v[76:79], v[120:123], v[28:31]
    v_mfma_f32_16x16x32_bf16 v[32:35], v[92:95], v[136:139], v[32:35]
    v_mfma_f32_16x16x32_bf16 v[36:39], v[76:79], v[136:139], v[36:39]
    v_mfma_f32_16x16x32_bf16 v[44:47], v[92:95], v[120:123], v[44:47]
    s_add_u32 s57, s56, 16384
    s_add_u32 s58, s56, 32768
    s_add_u32 s59, s56, 49152
    s_nop 7
    v_add_f32 v28, v28, v32
    v_sub_f32 v36, v36, v44
    v_add_f32 v29, v29, v33
    v_sub_f32 v37, v37, v45
    v_add_f32 v30, v30, v34
    v_sub_f32 v38, v38, v46
    v_add_f32 v31, v31, v35
    v_sub_f32 v39, v39, v47
    v_mul_f32 v32, v36, v100
    v_mul_f32 v44, v36, v96
    v_mul_f32 v33, v37, v101
    v_mul_f32 v45, v37, v97
    v_mul_f32 v34, v38, v102
    v_mul_f32 v46, v38, v98
    v_mul_f32 v35, v39, v103
    v_mul_f32 v47, v39, v99
    v_fma_f32 v32, v28, v96, -v32
    v_fma_f32 v44, v28, v100, v44
    v_fma_f32 v33, v29, v97, -v33
    v_fma_f32 v45, v29, v101, v45
    v_fma_f32 v34, v30, v98, -v34
    v_fma_f32 v46, v30, v102, v46
    v_fma_f32 v35, v31, v99, -v35
    v_fma_f32 v47, v31, v103, v47
    v_cvt_pk_bf16_f32 v48, v32, v44
    v_cvt_pk_bf16_f32 v49, v33, v45
    v_cvt_pk_bf16_f32 v50, v34, v46
    v_cvt_pk_bf16_f32 v51, v35, v47
    buffer_store_dword v48, v104, s[28:31], s56 offen sc1
    buffer_store_dword v49, v104, s[28:31], s57 offen sc1
    buffer_store_dword v50, v104, s[28:31], s58 offen sc1
    buffer_store_dword v51, v104, s[28:31], s59 offen sc1
L_r_done_1:
    s_endpgm
.globl c0_kernel
.p2align 8
.type c0_kernel,@function
c0_kernel:
    s_load_dwordx2 s[4:5], s[0:1], 0
    s_load_dwordx2 s[44:45], s[0:1], 88
    s_load_dwordx2 s[8:9], s[0:1], 48
    s_load_dwordx2 s[12:13], s[0:1], 56
    s_load_dwordx2 s[16:17], s[0:1], 64
    s_cmp_ge_u32 s2, 384
    s_cbranch_scc1 L_c_done_101
    s_cmp_ge_u32 s2, 256
    s_cbranch_scc1 L_c_pf_102
    s_bfe_u32 s62, s2, 0x10003
    s_lshr_b32 s63, s2, 4
    s_lshl_b32 s63, s63, 3
    s_and_b32 s2, s2, 7
    s_add_u32 s2, s2, s63
    v_lshrrev_b32 v1, 6, v0
    v_and_b32 v2, 63, v0
    v_readfirstlane_b32 s48, v1
    v_and_b32 v3, 15, v2
    v_lshrrev_b32 v4, 4, v2
    s_sub_u32 s46, 128, s2
    s_and_b32 s46, s46, 127
    s_cmp_ge_u32 s48, 4
    s_cselect_b32 s49, s46, s2
    s_lshl_b32 s49, s49, 4
    s_and_b32 s50, s48, 3
    s_lshl_b32 s50, s50, 2
    s_add_u32 s49, s49, s50
    s_lshl_b32 s49, s49, 10
    s_mul_i32 s51, s48, 4160
    v_lshlrev_b32 v5, 4, v2
    s_waitcnt lgkmcnt(0)
    s_mov_b32 s12, s44
    s_mov_b32 s13, s45
    s_mov_b32 s14, 2097152
    s_mov_b32 s15, 0x00020000
    s_add_u32 s52, s49, 0
    s_add_u32 m0, s51, 0
    s_nop 0
    buffer_load_dwordx4 v5, s[12:15], s52 offen lds
    s_add_u32 s52, s49, 1024
    s_add_u32 m0, s51, 1040
    s_nop 0
    buffer_load_dwordx4 v5, s[12:15], s52 offen lds
    s_add_u32 s52, s49, 2048
    s_add_u32 m0, s51, 2080
    s_nop 0
    buffer_load_dwordx4 v5, s[12:15], s52 offen lds
    s_add_u32 s52, s49, 3072
    s_add_u32 m0, s51, 3120
    s_nop 0
    buffer_load_dwordx4 v5, s[12:15], s52 offen lds
    s_mov_b32 s8, s4
    s_mov_b32 s9, s5
    s_mov_b32 s10, 2097152
    s_mov_b32 s11, 0x00020000
    s_add_u32 s16, s44, 2097152
    s_addc_u32 s17, s45, 0
    s_mov_b32 s18, 2097152
    s_mov_b32 s19, 0x00020000
    s_add_u32 s20, s44, 4194304
    s_addc_u32 s21, s45, 0
    s_mov_b32 s22, 2097152
    s_mov_b32 s23, 0x00020000
    s_and_b32 s52, s2, 15
    s_lshl_b32 s52, s52, 7
    s_lshr_b32 s53, s2, 4
    s_add_u32 s52, s52, s53
    s_lshl_b32 s63, s62, 3
    s_add_u32 s63, s63, s48
    s_lshl_b32 s53, s63, 3
    s_add_u32 s52, s52, s53
    s_lshl_b32 s58, s52, 10
    s_add_u32 s59, s58, 8192
    s_lshl_b32 s60, s63, 7
    s_add_u32 s60, s60, s2
    s_lshl_b32 s60, s60, 10
    s_add_u32 s61, s60, 131072
    v_lshlrev_b32 v6, 3, v2
    buffer_load_dwordx2 v[16:17], v6, s[8:11], s60 offen
    buffer_load_dwordx2 v[18:19], v6, s[8:11], s60 offen offset:512
    s_cmp_eq_u32 s2, 0
    s_cselect_b32 s54, 16, 15
    v_sub_u32 v7, s54, v3
    v_and_b32 v7, 15, v7
    s_cmp_ge_u32 s48, 4
    s_cselect_b64 vcc, -1, 0
    v_cndmask_b32 v7, v3, v7, vcc
    v_add_u32 v8, 0, v4
    v_mul_u32_u24 v8, v8, v7
    v_and_b32 v8, 15, v8
    v_cvt_f32_u32 v8, v8
    v_mul_f32 v8, 0x3d800000, v8
    v_cos_f32 v9, v8
    v_sin_f32 v10, v8
    s_nop 0
    v_cvt_pk_bf16_f32 v24, v9, v10
    v_add_u32 v8, 4, v4
    v_mul_u32_u24 v8, v8, v7
    v_and_b32 v8, 15, v8
    v_cvt_f32_u32 v8, v8
    v_mul_f32 v8, 0x3d800000, v8
    v_cos_f32 v9, v8
    v_sin_f32 v10, v8
    s_nop 0
    v_cvt_pk_bf16_f32 v25, v9, v10
    v_add_u32 v8, 8, v4
    v_mul_u32_u24 v8, v8, v7
    v_and_b32 v8, 15, v8
    v_cvt_f32_u32 v8, v8
    v_mul_f32 v8, 0x3d800000, v8
    v_cos_f32 v9, v8
    v_sin_f32 v10, v8
    s_nop 0
    v_cvt_pk_bf16_f32 v26, v9, v10
    v_add_u32 v8, 12, v4
    v_mul_u32_u24 v8, v8, v7
    v_and_b32 v8, 15, v8
    v_cvt_f32_u32 v8, v8
    v_mul_f32 v8, 0x3d800000, v8
    v_cos_f32 v9, v8
    v_sin_f32 v10, v8
    s_nop 0
    v_cvt_pk_bf16_f32 v27, v9, v10
    v_lshrrev_b32 v8, 2, v3
    v_lshlrev_b32 v8, 4, v8
    v_and_b32 v9, 3, v3
    v_add_u32 v8, v8, v9
    s_lshl_b32 s53, s48, 6
    v_add_u32 v8, s53, v8
    v_add_u32 v9, 0, v8
    v_sub_u32 v10, 512, v9
    v_and_b32 v10, 255, v10
    v_cndmask_b32 v9, v9, v10, vcc
    v_lshlrev_b32 v28, 2, v9
    v_add_u32 v9, 4, v8
    v_sub_u32 v10, 512, v9
    v_and_b32 v10, 255, v10
    v_cndmask_b32 v9, v9, v10, vcc
    v_lshlrev_b32 v29, 2, v9
    v_add_u32 v9, 8, v8
    v_sub_u32 v10, 512, v9
    v_and_b32 v10, 255, v10
    v_cndmask_b32 v9, v9, v10, vcc
    v_lshlrev_b32 v30, 2, v9
    v_add_u32 v9, 12, v8
    v_sub_u32 v10, 512, v9
    v_and_b32 v10, 255, v10
    v_cndmask_b32 v9, v9, v10, vcc
    v_lshlrev_b32 v31, 2, v9
    v_mul_u32_u24 v9, 1040, v4
    s_cmp_ge_u32 s48, 4
    s_cselect_b32 s55, 16640, 0
    v_add_u32 v9, s55, v9
    v_add_u32 v28, v28, v9
    v_add_u32 v29, v29, v9
    v_add_u32 v30, v30, v9
    v_add_u32 v31, v31, v9
    v_mov_b32 v32, 0
    v_mov_b32 v33, 0
    v_mov_b32 v34, 0
    v_mov_b32 v35, 0
    v_mov_b32 v36, 0
    v_mov_b32 v37, 0
    v_mov_b32 v38, 0
    v_mov_b32 v39, 0
    v_mov_b32 v40, 0
    v_mov_b32 v41, 0
    v_mov_b32 v42, 0
    v_mov_b32 v43, 0
    v_mov_b32 v44, 0
    v_mov_b32 v45, 0
    v_mov_b32 v46, 0
    v_mov_b32 v47, 0
    v_mul_u32_u24 v11, 2064, v3
    v_lshl_add_u32 v11, v4, 6, v11
    s_lshl_b32 s53, s48, 8
    s_add_u32 s53, s53, 33280
    v_add_u32 v11, s53, v11
    s_mul_i32 s53, s63, 2064
    s_add_u32 s53, s53, 33280
    v_lshlrev_b32 v12, 4, v2
    v_add_u32 v12, s53, v12
    s_waitcnt vmcnt(2)
    s_barrier
    ds_read_b32 v48, v28 offset:0
    ds_read_b32 v49, v28 offset:4160
    ds_read_b32 v50, v28 offset:8320
    ds_read_b32 v51, v28 offset:12480
    ds_read_b32 v52, v29 offset:0
    ds_read_b32 v53, v29 offset:4160
    ds_read_b32 v54, v29 offset:8320
    ds_read_b32 v55, v29 offset:12480
    ds_read_b32 v56, v30 offset:0
    ds_read_b32 v57, v30 offset:4160
    ds_read_b32 v58, v30 offset:8320
    ds_read_b32 v59, v30 offset:12480
    ds_read_b32 v60, v31 offset:0
    ds_read_b32 v61, v31 offset:4160
    ds_read_b32 v62, v31 offset:8320
    ds_read_b32 v63, v31 offset:12480
    s_waitcnt lgkmcnt(12)
    v_mfma_f32_16x16x32_bf16 v[32:35], v[48:51], v[24:27], v[32:35]
    s_waitcnt lgkmcnt(8)
    v_mfma_f32_16x16x32_bf16 v[36:39], v[52:55], v[24:27], v[36:39]
    s_waitcnt lgkmcnt(4)
    v_mfma_f32_16x16x32_bf16 v[40:43], v[56:59], v[24:27], v[40:43]
    s_waitcnt lgkmcnt(0)
    v_mfma_f32_16x16x32_bf16 v[44:47], v[60:63], v[24:27], v[44:47]
    v_cmp_gt_u32 s[56:57], 16, v0
    s_nop 7
    v_cndmask_b32 v32, v32, 0, s[56:57]
    s_nop 0
    ds_write_b128 v11, v[32:35] offset:0
    ds_write_b128 v11, v[36:39] offset:16
    ds_write_b128 v11, v[40:43] offset:32
    ds_write_b128 v11, v[44:47] offset:48
    s_waitcnt lgkmcnt(0)
    s_barrier
    ds_read_b128 v[48:51], v12
    ds_read_b128 v[52:55], v12 offset:1024
    s_waitcnt vmcnt(0)
    v_lshlrev_b32 v64, 16, v16
    v_and_b32 v65, 0xffff0000, v16
    v_lshlrev_b32 v66, 16, v17
    v_and_b32 v67, 0xffff0000, v17
    v_lshlrev_b32 v68, 16, v18
    v_and_b32 v69, 0xffff0000, v18
    v_lshlrev_b32 v70, 16, v19
    v_and_b32 v71, 0xffff0000, v19
    s_waitcnt lgkmcnt(0)
    v_add_f32 v64, v64, v48
    v_add_f32 v65, v65, v49
    v_add_f32 v66, v66, v50
    v_add_f32 v67, v67, v51
    v_add_f32 v68, v68, v52
    v_add_f32 v69, v69, v53
    v_add_f32 v70, v70, v54
    v_add_f32 v71, v71, v55
    v_cvt_pk_bf16_f32 v32, v64, v65
    v_cvt_pk_bf16_f32 v33, v66, v67
    v_cvt_pk_bf16_f32 v34, v68, v69
    v_cvt_pk_bf16_f32 v35, v70, v71
    buffer_store_dwordx2 v[32:33], v6, s[16:19], s58 offen sc1
    buffer_store_dwordx2 v[34:35], v6, s[16:19], s58 offen offset:512 sc1
    v_add_f32 v8, v64, v65
    v_mul_f32 v9, v64, v64
    v_fma_f32 v9, v65, v65, v9
    v_add_f32 v8, v8, v66
    v_fma_f32 v9, v66, v66, v9
    v_add_f32 v8, v8, v67
    v_fma_f32 v9, v67, v67, v9
    v_add_f32 v8, v8, v68
    v_fma_f32 v9, v68, v68, v9
    v_add_f32 v8, v8, v69
    v_fma_f32 v9, v69, v69, v9
    v_add_f32 v8, v8, v70
    v_fma_f32 v9, v70, v70, v9
    v_add_f32 v8, v8, v71
    v_fma_f32 v9, v71, v71, v9
    s_nop 1
    v_add_f32_dpp v8, v8, v8 row_ror:8 row_mask:0xf bank_mask:0xf
    v_add_f32_dpp v9, v9, v9 row_ror:8 row_mask:0xf bank_mask:0xf
    s_nop 0
    v_add_f32_dpp v8, v8, v8 row_ror:4 row_mask:0xf bank_mask:0xf
    v_add_f32_dpp v9, v9, v9 row_ror:4 row_mask:0xf bank_mask:0xf
    s_nop 0
    v_add_f32_dpp v8, v8, v8 row_ror:2 row_mask:0xf bank_mask:0xf
    v_add_f32_dpp v9, v9, v9 row_ror:2 row_mask:0xf bank_mask:0xf
    s_nop 0
    v_add_f32_dpp v8, v8, v8 row_ror:1 row_mask:0xf bank_mask:0xf
    v_add_f32_dpp v9, v9, v9 row_ror:1 row_mask:0xf bank_mask:0xf
    s_nop 0
    v_mov_b32 v40, v8
    v_mov_b32 v41, v9
    s_nop 1
    v_permlane16_swap_b32 v8, v40
    v_permlane16_swap_b32 v9, v41
    s_nop 1
    v_add_f32 v8, v8, v40
    v_add_f32 v9, v9, v41
    v_mov_b32 v40, v8
    v_mov_b32 v41, v9
    s_nop 1
    v_permlane32_swap_b32 v8, v40
    v_permlane32_swap_b32 v9, v41
    s_nop 1
    v_add_f32 v8, v8, v40
    v_add_f32 v9, v9, v41
    v_mul_f32 v8, 0x3b000000, v8
    v_mul_f32 v9, 0x3b000000, v9
    v_fma_f32 v9, -v8, v8, v9
    v_add_f32 v9, 0x3727c5ac, v9
    v_rsq_f32 v9, v9
    s_nop 0
    v_mul_f32 v8, v8, v9
    v_sub_f32 v8, 0, v8
    v_fma_f32 v64, v64, v9, v8
    v_fma_f32 v65, v65, v9, v8
    v_fma_f32 v66, v66, v9, v8
    v_fma_f32 v67, v67, v9, v8
    v_fma_f32 v68, v68, v9, v8
    v_fma_f32 v69, v69, v9, v8
    v_fma_f32 v70, v70, v9, v8
    v_fma_f32 v71, v71, v9, v8
    v_cvt_pk_bf16_f32 v48, v64, v65
    v_cvt_pk_bf16_f32 v49, v66, v67
    v_cvt_pk_bf16_f32 v50, v68, v69
    v_cvt_pk_bf16_f32 v51, v70, v71
    buffer_store_dwordx2 v[48:49], v6, s[20:23], s58 offen sc1
    buffer_store_dwordx2 v[50:51], v6, s[20:23], s58 offen offset:512 sc1
    s_endpgm
L_c_pf_102:
    s_sub_u32 s20, s2, 256
    s_mul_i32 s20, s20, 14336
    s_add_u32 s21, s20, 8192
    v_lshlrev_b32 v1, 4, v0
    s_waitcnt lgkmcnt(0)
    s_mov_b32 s10, 1835008
    s_mov_b32 s11, 0x00020000
    s_mov_b32 s14, 1835008
    s_mov_b32 s15, 0x00020000
    s_mov_b32 s18, 1835008
    s_mov_b32 s19, 0x00020000
    buffer_load_dwordx4 v[4:7], v1, s[8:11], s20 offen
    buffer_load_dwordx4 v[8:11], v1, s[8:11], s21 offen
    buffer_load_dwordx4 v[12:15], v1, s[12:15], s20 offen
    buffer_load_dwordx4 v[16:19], v1, s[12:15], s21 offen
    s_waitcnt vmcnt(0)
L_c_done_101:
    s_endpgm
.globl g1_kernel
.p2align 8
.type g1_kernel,@function
g1_kernel:
    s_load_dwordx2 s[4:5], s[0:1], 48
    s_load_dwordx2 s[6:7], s[0:1], 56
    s_load_dwordx2 s[44:45], s[0:1], 88
    s_cmp_ge_u32 s2, 256
    s_cbranch_scc1 L_g1_done_201
    s_cmp_ge_u32 s2, 224
    s_cbranch_scc1 L_g1_cp_202
    s_and_b32 s46, s2, 7
    s_lshr_b32 s47, s2, 3
    s_lshr_b32 s49, s46, 1
    s_lshl_b32 s49, s49, 2
    s_and_b32 s50, s47, 3
    s_add_u32 s49, s49, s50
    s_and_b32 s50, s46, 1
    s_mul_i32 s50, s50, 7
    s_lshr_b32 s51, s47, 2
    s_add_u32 s50, s50, s51
    v_lshrrev_b32 v1, 6, v0
    v_and_b32 v2, 63, v0
    v_readfirstlane_b32 s48, v1
    v_lshrrev_b32 v3, 3, v2
    s_lshl_b32 s51, s48, 3
    v_add_u32 v3, s51, v3
    v_lshlrev_b32 v3, 10, v3
    v_lshrrev_b32 v4, 4, v2
    s_and_b32 s51, s48, 1
    s_lshl_b32 s51, s51, 2
    v_add_u32 v5, s51, v4
    v_and_b32 v6, 7, v2
    v_xor_b32 v5, v5, v6
    v_lshl_add_u32 v10, v5, 4, v3
    s_lshl_b32 s51, s48, 2
    v_add_u32 v3, s51, v4
    v_mul_u32_u24 v3, 3584, v3
    v_and_b32 v5, 15, v2
    v_lshlrev_b32 v6, 2, v4
    v_xor_b32 v5, v5, v6
    v_lshl_add_u32 v11, v5, 4, v3
    s_lshl_b32 s52, s49, 17
    s_lshl_b32 s53, s50, 8
    s_lshl_b32 s54, s48, 10
    s_waitcnt lgkmcnt(0)
    s_add_u32 s8, s44, 4194304
    s_addc_u32 s9, s45, 0
    s_mov_b32 s10, 2097152
    s_mov_b32 s11, 0x00020000
    s_mov_b32 s12, s4
    s_mov_b32 s13, s5
    s_mov_b32 s14, 1835008
    s_mov_b32 s15, 0x00020000
    s_mov_b32 s16, s6
    s_mov_b32 s17, s7
    s_mov_b32 s18, 1835008
    s_mov_b32 s19, 0x00020000
    s_add_u32 m0, s54, 0
    s_add_u32 s55, s52, 0
    buffer_load_dwordx4 v10, s[8:11], s55 offen lds
    s_add_u32 m0, s54, 8192
    s_add_u32 s55, s52, 65536
    buffer_load_dwordx4 v10, s[8:11], s55 offen lds
    s_add_u32 m0, s54, 16384
    s_add_u32 s55, s53, 0
    buffer_load_dwordx4 v11, s[12:15], s55 offen lds
    s_add_u32 m0, s54, 24576
    s_add_u32 s55, s53, 114688
    buffer_load_dwordx4 v11, s[12:15], s55 offen lds
    s_add_u32 m0, s54, 32768
    s_add_u32 s55, s53, 0
    buffer_load_dwordx4 v11, s[16:19], s55 offen lds
    s_add_u32 m0, s54, 40960
    s_add_u32 s55, s53, 114688
    buffer_load_dwordx4 v11, s[16:19], s55 offen lds
    s_add_u32 m0, s54, 49152
    s_add_u32 s55, s52, 128
    buffer_load_dwordx4 v10, s[8:11], s55 offen lds
    s_add_u32 s20, s44, 6291456
    s_addc_u32 s21, s45, 0
    s_mov_b32 s22, 7340032
    s_mov_b32 s23, 0x00020000
    s_and_b32 s56, s48, 3
    s_lshr_b32 s57, s48, 2
    s_add_u32 m0, s54, 57344
    s_add_u32 s55, s52, 65664
    buffer_load_dwordx4 v10, s[8:11], s55 offen lds
    v_and_b32 v3, 31, v2
    v_lshrrev_b32 v4, 5, v2
    s_lshl_b32 s51, s57, 6
    v_add_u32 v5, s51, v3
    v_lshrrev_b32 v6, 1, v5
    v_and_b32 v6, 7, v6
    s_add_u32 m0, s54, 65536
    s_add_u32 s55, s53, 229376
    buffer_load_dwordx4 v11, s[12:15], s55 offen lds
    v_lshlrev_b32 v5, 7, v5
    v_add_u32 v7, 0, v4
    v_xor_b32 v7, v7, v6
    v_lshl_add_u32 v12, v7, 4, v5
    v_add_u32 v7, 2, v4
    v_xor_b32 v7, v7, v6
    s_add_u32 m0, s54, 73728
    s_add_u32 s55, s53, 344064
    buffer_load_dwordx4 v11, s[12:15], s55 offen lds
    v_lshl_add_u32 v13, v7, 4, v5
    v_add_u32 v7, 4, v4
    v_xor_b32 v7, v7, v6
    v_lshl_add_u32 v14, v7, 4, v5
    v_add_u32 v7, 6, v4
    v_xor_b32 v7, v7, v6
    s_add_u32 m0, s54, 81920
    s_add_u32 s55, s53, 229376
    buffer_load_dwordx4 v11, s[16:19], s55 offen lds
    v_lshl_add_u32 v15, v7, 4, v5
    v_add_u32 v16, 49152, v12
    v_add_u32 v17, 49152, v13
    v_add_u32 v18, 49152, v14
    v_add_u32 v19, 49152, v15
    v_add_u32 v20, 98304, v12
    s_add_u32 m0, s54, 90112
    s_add_u32 s55, s53, 344064
    buffer_load_dwordx4 v11, s[16:19], s55 offen lds
    v_add_u32 v21, 98304, v13
    v_add_u32 v22, 98304, v14
    v_add_u32 v23, 98304, v15
    v_and_b32 v5, 15, v2
    v_lshrrev_b32 v5, 2, v5
    v_lshl_add_u32 v6, v4, 3, v5
    s_add_u32 m0, s54, 98304
    s_add_u32 s55, s52, 256
    buffer_load_dwordx4 v10, s[8:11], s55 offen lds
    v_lshlrev_b32 v6, 8, v6
    v_xor_b32 v7, s56, v5
    v_lshlrev_b32 v7, 2, v7
    v_bfe_u32 v8, v2, 4, 1
    v_lshl_add_u32 v7, v8, 1, v7
    v_bfe_u32 v8, v2, 1, 1
    s_add_u32 m0, s54, 106496
    s_add_u32 s55, s52, 65792
    buffer_load_dwordx4 v10, s[8:11], s55 offen lds
    v_add_u32 v7, v7, v8
    v_lshl_add_u32 v6, v7, 4, v6
    v_and_b32 v8, 1, v2
    v_lshl_add_u32 v6, v8, 3, v6
    v_add_u32 v24, 16384, v6
    v_add_u32 v25, 49152, v24
    v_add_u32 v26, 98304, v24
    s_waitcnt vmcnt(8)
    s_barrier
    ds_read_b64_tr_b16 v[32:33], v24 offset:0
    ds_read_b64_tr_b16 v[34:35], v24 offset:1024
    ds_read_b128 v[40:43], v12
    ds_read_b128 v[44:47], v12 offset:4096
    ds_read_b64_tr_b16 v[36:37], v24 offset:16384
    ds_read_b64_tr_b16 v[38:39], v24 offset:17408
    ds_read_b64_tr_b16 v[48:49], v24 offset:4096
    ds_read_b64_tr_b16 v[50:51], v24 offset:5120
    ds_read_b128 v[56:59], v13
    ds_read_b128 v[60:63], v13 offset:4096
    ds_read_b64_tr_b16 v[52:53], v24 offset:20480
    ds_read_b64_tr_b16 v[54:55], v24 offset:21504
    s_waitcnt lgkmcnt(6)
    v_mfma_f32_32x32x16_bf16 v[64:79], v[32:35], v[40:43], 0
    s_add_u32 m0, s54, 114688
    s_add_u32 s55, s53, 458752
    buffer_load_dwordx4 v11, s[12:15], s55 offen lds
    v_mfma_f32_32x32x16_bf16 v[80:95], v[32:35], v[44:47], 0
    v_mfma_f32_32x32x16_bf16 v[96:111], v[36:39], v[40:43], 0
    s_add_u32 m0, s54, 122880
    s_add_u32 s55, s53, 573440
    buffer_load_dwordx4 v11, s[12:15], s55 offen lds
    v_mfma_f32_32x32x16_bf16 v[112:127], v[36:39], v[44:47], 0
    ds_read_b64_tr_b16 v[32:33], v24 offset:8192
    ds_read_b64_tr_b16 v[34:35], v24 offset:9216
    ds_read_b128 v[40:43], v14
    ds_read_b128 v[44:47], v14 offset:4096
    ds_read_b64_tr_b16 v[36:37], v24 offset:24576
    ds_read_b64_tr_b16 v[38:39], v24 offset:25600
    s_waitcnt lgkmcnt(6)
    v_mfma_f32_32x32x16_bf16 v[64:79], v[48:51], v[56:59], v[64:79]
    s_add_u32 m0, s54, 131072
    s_add_u32 s55, s53, 458752
    buffer_load_dwordx4 v11, s[16:19], s55 offen lds
    v_mfma_f32_32x32x16_bf16 v[80:95], v[48:51], v[60:63], v[80:95]
    v_mfma_f32_32x32x16_bf16 v[96:111], v[52:55], v[56:59], v[96:111]
    s_add_u32 m0, s54, 139264
    s_add_u32 s55, s53, 573440
    buffer_load_dwordx4 v11, s[16:19], s55 offen lds
    v_mfma_f32_32x32x16_bf16 v[112:127], v[52:55], v[60:63], v[112:127]
    ds_read_b64_tr_b16 v[48:49], v24 offset:12288
    ds_read_b64_tr_b16 v[50:51], v24 offset:13312
    ds_read_b128 v[56:59], v15
    ds_read_b128 v[60:63], v15 offset:4096
    ds_read_b64_tr_b16 v[52:53], v24 offset:28672
    ds_read_b64_tr_b16 v[54:55], v24 offset:29696
    s_waitcnt lgkmcnt(6)
    v_mfma_f32_32x32x16_bf16 v[64:79], v[32:35], v[40:43], v[64:79]
    v_mfma_f32_32x32x16_bf16 v[80:95], v[32:35], v[44:47], v[80:95]
    v_mfma_f32_32x32x16_bf16 v[96:111], v[36:39], v[40:43], v[96:111]
    v_mfma_f32_32x32x16_bf16 v[112:127], v[36:39], v[44:47], v[112:127]
    s_waitcnt vmcnt(6) lgkmcnt(0)
    s_barrier
    ds_read_b64_tr_b16 v[32:33], v25 offset:0
    ds_read_b64_tr_b16 v[34:35], v25 offset:1024
    ds_read_b128 v[40:43], v16
    ds_read_b128 v[44:47], v16 offset:4096
    ds_read_b64_tr_b16 v[36:37], v25 offset:16384
    ds_read_b64_tr_b16 v[38:39], v25 offset:17408
    v_mfma_f32_32x32x16_bf16 v[64:79], v[48:51], v[56:59], v[64:79]
    s_add_u32 m0, s54, 0
    s_add_u32 s55, s52, 384
    buffer_load_dwordx4 v10, s[8:11], s55 offen lds
    v_mfma_f32_32x32x16_bf16 v[80:95], v[48:51], v[60:63], v[80:95]
    v_mfma_f32_32x32x16_bf16 v[96:111], v[52:55], v[56:59], v[96:111]
    s_add_u32 m0, s54, 8192
    s_add_u32 s55, s52, 65920
    buffer_load_dwordx4 v10, s[8:11], s55 offen lds
    v_mfma_f32_32x32x16_bf16 v[112:127], v[52:55], v[60:63], v[112:127]
    ds_read_b64_tr_b16 v[48:49], v25 offset:4096
    ds_read_b64_tr_b16 v[50:51], v25 offset:5120
    ds_read_b128 v[56:59], v17
    ds_read_b128 v[60:63], v17 offset:4096
    ds_read_b64_tr_b16 v[52:53], v25 offset:20480
    ds_read_b64_tr_b16 v[54:55], v25 offset:21504
    s_waitcnt lgkmcnt(6)
    v_mfma_f32_32x32x16_bf16 v[64:79], v[32:35], v[40:43], v[64:79]
    s_add_u32 m0, s54, 16384
    s_add_u32 s55, s53, 688128
    buffer_load_dwordx4 v11, s[12:15], s55 offen lds
    v_mfma_f32_32x32x16_bf16 v[80:95], v[32:35], v[44:47], v[80:95]
    v_mfma_f32_32x32x16_bf16 v[96:111], v[36:39], v[40:43], v[96:111]
    s_add_u32 m0, s54, 24576
    s_add_u32 s55, s53, 802816
    buffer_load_dwordx4 v11, s[12:15], s55 offen lds
    v_mfma_f32_32x32x16_bf16 v[112:127], v[36:39], v[44:47], v[112:127]
    ds_read_b64_tr_b16 v[32:33], v25 offset:8192
    ds_read_b64_tr_b16 v[34:35], v25 offset:9216
    ds_read_b128 v[40:43], v18
    ds_read_b128 v[44:47], v18 offset:4096
    ds_read_b64_tr_b16 v[36:37], v25 offset:24576
    ds_read_b64_tr_b16 v[38:39], v25 offset:25600
    s_waitcnt lgkmcnt(6)
    v_mfma_f32_32x32x16_bf16 v[64:79], v[48:51], v[56:59], v[64:79]
    s_add_u32 m0, s54, 32768
    s_add_u32 s55, s53, 688128
    buffer_load_dwordx4 v11, s[16:19], s55 offen lds
    v_mfma_f32_32x32x16_bf16 v[80:95], v[48:51], v[60:63], v[80:95]
    v_mfma_f32_32x32x16_bf16 v[96:111], v[52:55], v[56:59], v[96:111]
    s_add_u32 m0, s54, 40960
    s_add_u32 s55, s53, 802816
    buffer_load_dwordx4 v11, s[16:19], s55 offen lds
    v_mfma_f32_32x32x16_bf16 v[112:127], v[52:55], v[60:63], v[112:127]
    ds_read_b64_tr_b16 v[48:49], v25 offset:12288
    ds_read_b64_tr_b16 v[50:51], v25 offset:13312
    ds_read_b128 v[56:59], v19
    ds_read_b128 v[60:63], v19 offset:4096
    ds_read_b64_tr_b16 v[52:53], v25 offset:28672
    ds_read_b64_tr_b16 v[54:55], v25 offset:29696
    s_waitcnt lgkmcnt(6)
    v_mfma_f32_32x32x16_bf16 v[64:79], v[32:35], v[40:43], v[64:79]
    v_mfma_f32_32x32x16_bf16 v[80:95], v[32:35], v[44:47], v[80:95]
    v_mfma_f32_32x32x16_bf16 v[96:111], v[36:39], v[40:43], v[96:111]
    v_mfma_f32_32x32x16_bf16 v[112:127], v[36:39], v[44:47], v[112:127]
    s_waitcnt vmcnt(6) lgkmcnt(0)
    s_barrier
    ds_read_b64_tr_b16 v[32:33], v26 offset:0
    ds_read_b64_tr_b16 v[34:35], v26 offset:1024
    ds_read_b128 v[40:43], v20
    ds_read_b128 v[44:47], v20 offset:4096
    ds_read_b64_tr_b16 v[36:37], v26 offset:16384
    ds_read_b64_tr_b16 v[38:39], v26 offset:17408
    v_mfma_f32_32x32x16_bf16 v[64:79], v[48:51], v[56:59], v[64:79]
    s_add_u32 m0, s54, 49152
    s_add_u32 s55, s52, 512
    buffer_load_dwordx4 v10, s[8:11], s55 offen lds
    v_mfma_f32_32x32x16_bf16 v[80:95], v[48:51], v[60:63], v[80:95]
    v_mfma_f32_32x32x16_bf16 v[96:111], v[52:55], v[56:59], v[96:111]
    s_add_u32 m0, s54, 57344
    s_add_u32 s55, s52, 66048
    buffer_load_dwordx4 v10, s[8:11], s55 offen lds
    v_mfma_f32_32x32x16_bf16 v[112:127], v[52:55], v[60:63], v[112:127]
    ds_read_b64_tr_b16 v[48:49], v26 offset:4096
    ds_read_b64_tr_b16 v[50:51], v26 offset:5120
    ds_read_b128 v[56:59], v21
    ds_read_b128 v[60:63], v21 offset:4096
    ds_read_b64_tr_b16 v[52:53], v26 offset:20480
    ds_read_b64_tr_b16 v[54:55], v26 offset:21504
    s_waitcnt lgkmcnt(6)
    v_mfma_f32_32x32x16_bf16 v[64:79], v[32:35], v[40:43], v[64:79]
    s_add_u32 m0, s54, 65536
    s_add_u32 s55, s53, 917504
    buffer_load_dwordx4 v11, s[12:15], s55 offen lds
    v_mfma_f32_32x32x16_bf16 v[80:95], v[32:35], v[44:47], v[80:95]
    v_mfma_f32_32x32x16_bf16 v[96:111], v[36:39], v[40:43], v[96:111]
    s_add_u32 m0, s54, 73728
    s_add_u32 s55, s53, 1032192
    buffer_load_dwordx4 v11, s[12:15], s55 offen lds
    v_mfma_f32_32x32x16_bf16 v[112:127], v[36:39], v[44:47], v[112:127]
    ds_read_b64_tr_b16 v[32:33], v26 offset:8192
    ds_read_b64_tr_b16 v[34:35], v26 offset:9216
    ds_read_b128 v[40:43], v22
    ds_read_b128 v[44:47], v22 offset:4096
    ds_read_b64_tr_b16 v[36:37], v26 offset:24576
    ds_read_b64_tr_b16 v[38:39], v26 offset:25600
    s_waitcnt lgkmcnt(6)
    v_mfma_f32_32x32x16_bf16 v[64:79], v[48:51], v[56:59], v[64:79]
    s_add_u32 m0, s54, 81920
    s_add_u32 s55, s53, 917504
    buffer_load_dwordx4 v11, s[16:19], s55 offen lds
    v_mfma_f32_32x32x16_bf16 v[80:95], v[48:51], v[60:63], v[80:95]
    v_mfma_f32_32x32x16_bf16 v[96:111], v[52:55], v[56:59], v[96:111]
    s_add_u32 m0, s54, 90112
    s_add_u32 s55, s53, 1032192
    buffer_load_dwordx4 v11, s[16:19], s55 offen lds
    v_mfma_f32_32x32x16_bf16 v[112:127], v[52:55], v[60:63], v[112:127]
    ds_read_b64_tr_b16 v[48:49], v26 offset:12288
    ds_read_b64_tr_b16 v[50:51], v26 offset:13312
    ds_read_b128 v[56:59], v23
    ds_read_b128 v[60:63], v23 offset:4096
    ds_read_b64_tr_b16 v[52:53], v26 offset:28672
    ds_read_b64_tr_b16 v[54:55], v26 offset:29696
    s_waitcnt lgkmcnt(6)
    v_mfma_f32_32x32x16_bf16 v[64:79], v[32:35], v[40:43], v[64:79]
    v_mfma_f32_32x32x16_bf16 v[80:95], v[32:35], v[44:47], v[80:95]
    v_mfma_f32_32x32x16_bf16 v[96:111], v[36:39], v[40:43], v[96:111]
    v_mfma_f32_32x32x16_bf16 v[112:127], v[36:39], v[44:47], v[112:127]
    s_waitcnt vmcnt(6) lgkmcnt(0)
    s_barrier
    ds_read_b64_tr_b16 v[32:33], v24 offset:0
    ds_read_b64_tr_b16 v[34:35], v24 offset:1024
    ds_read_b128 v[40:43], v12
    ds_read_b128 v[44:47], v12 offset:4096
    ds_read_b64_tr_b16 v[36:37], v24 offset:16384
    ds_read_b64_tr_b16 v[38:39], v24 offset:17408
    v_mfma_f32_32x32x16_bf16 v[64:79], v[48:51], v[56:59], v[64:79]
    s_add_u32 m0, s54, 98304
    s_add_u32 s55, s52, 640
    buffer_load_dwordx4 v10, s[8:11], s55 offen lds
    v_mfma_f32_32x32x16_bf16 v[80:95], v[48:51], v[60:63], v[80:95]
    v_mfma_f32_32x32x16_bf16 v[96:111], v[52:55], v[56:59], v[96:111]
    s_add_u32 m0, s54, 106496
    s_add_u32 s55, s52, 66176
    buffer_load_dwordx4 v10, s[8:11], s55 offen lds
    v_mfma_f32_32x32x16_bf16 v[112:127], v[52:55], v[60:63], v[112:127]
    ds_read_b64_tr_b16 v[48:49], v24 offset:4096
    ds_read_b64_tr_b16 v[50:51], v24 offset:5120
    ds_read_b128 v[56:59], v13
    ds_read_b128 v[60:63], v13 offset:4096
    ds_read_b64_tr_b16 v[52:53], v24 offset:20480
    ds_read_b64_tr_b16 v[54:55], v24 offset:21504
    s_waitcnt lgkmcnt(6)
    v_mfma_f32_32x32x16_bf16 v[64:79], v[32:35], v[40:43], v[64:79]
    s_add_u32 m0, s54, 114688
    s_add_u32 s55, s53, 1146880
    buffer_load_dwordx4 v11, s[12:15], s55 offen lds
    v_mfma_f32_32x32x16_bf16 v[80:95], v[32:35], v[44:47], v[80:95]
    v_mfma_f32_32x32x16_bf16 v[96:111], v[36:39], v[40:43], v[96:111]
    s_add_u32 m0, s54, 122880
    s_add_u32 s55, s53, 1261568
    buffer_load_dwordx4 v11, s[12:15], s55 offen lds
    v_mfma_f32_32x32x16_bf16 v[112:127], v[36:39], v[44:47], v[112:127]
    ds_read_b64_tr_b16 v[32:33], v24 offset:8192
    ds_read_b64_tr_b16 v[34:35], v24 offset:9216
    ds_read_b128 v[40:43], v14
    ds_read_b128 v[44:47], v14 offset:4096
    ds_read_b64_tr_b16 v[36:37], v24 offset:24576
    ds_read_b64_tr_b16 v[38:39], v24 offset:25600
    s_waitcnt lgkmcnt(6)
    v_mfma_f32_32x32x16_bf16 v[64:79], v[48:51], v[56:59], v[64:79]
    s_add_u32 m0, s54, 131072
    s_add_u32 s55, s53, 1146880
    buffer_load_dwordx4 v11, s[16:19], s55 offen lds
    v_mfma_f32_32x32x16_bf16 v[80:95], v[48:51], v[60:63], v[80:95]
    v_mfma_f32_32x32x16_bf16 v[96:111], v[52:55], v[56:59], v[96:111]
    s_add_u32 m0, s54, 139264
    s_add_u32 s55, s53, 1261568
    buffer_load_dwordx4 v11, s[16:19], s55 offen lds
    v_mfma_f32_32x32x16_bf16 v[112:127], v[52:55], v[60:63], v[112:127]
    ds_read_b64_tr_b16 v[48:49], v24 offset:12288
    ds_read_b64_tr_b16 v[50:51], v24 offset:13312
    ds_read_b128 v[56:59], v15
    ds_read_b128 v[60:63], v15 offset:4096
    ds_read_b64_tr_b16 v[52:53], v24 offset:28672
    ds_read_b64_tr_b16 v[54:55], v24 offset:29696
    s_waitcnt lgkmcnt(6)
    v_mfma_f32_32x32x16_bf16 v[64:79], v[32:35], v[40:43], v[64:79]
    v_mfma_f32_32x32x16_bf16 v[80:95], v[32:35], v[44:47], v[80:95]
    v_mfma_f32_32x32x16_bf16 v[96:111], v[36:39], v[40:43], v[96:111]
    v_mfma_f32_32x32x16_bf16 v[112:127], v[36:39], v[44:47], v[112:127]
    s_waitcnt vmcnt(6) lgkmcnt(0)
    s_barrier
    ds_read_b64_tr_b16 v[32:33], v25 offset:0
    ds_read_b64_tr_b16 v[34:35], v25 offset:1024
    ds_read_b128 v[40:43], v16
    ds_read_b128 v[44:47], v16 offset:4096
    ds_read_b64_tr_b16 v[36:37], v25 offset:16384
    ds_read_b64_tr_b16 v[38:39], v25 offset:17408
    v_mfma_f32_32x32x16_bf16 v[64:79], v[48:51], v[56:59], v[64:79]
    s_add_u32 m0, s54, 0
    s_add_u32 s55, s52, 768
    buffer_load_dwordx4 v10, s[8:11], s55 offen lds
    v_mfma_f32_32x32x16_bf16 v[80:95], v[48:51], v[60:63], v[80:95]
    v_mfma_f32_32x32x16_bf16 v[96:111], v[52:55], v[56:59], v[96:111]
    s_add_u32 m0, s54, 8192
    s_add_u32 s55, s52, 66304
    buffer_load_dwordx4 v10, s[8:11], s55 offen lds
    v_mfma_f32_32x32x16_bf16 v[112:127], v[52:55], v[60:63], v[112:127]
    ds_read_b64_tr_b16 v[48:49], v25 offset:4096
    ds_read_b64_tr_b16 v[50:51], v25 offset:5120
    ds_read_b128 v[56:59], v17
    ds_read_b128 v[60:63], v17 offset:4096
    ds_read_b64_tr_b16 v[52:53], v25 offset:20480
    ds_read_b64_tr_b16 v[54:55], v25 offset:21504
    s_waitcnt lgkmcnt(6)
    v_mfma_f32_32x32x16_bf16 v[64:79], v[32:35], v[40:43], v[64:79]
    s_add_u32 m0, s54, 16384
    s_add_u32 s55, s53, 1376256
    buffer_load_dwordx4 v11, s[12:15], s55 offen lds
    v_mfma_f32_32x32x16_bf16 v[80:95], v[32:35], v[44:47], v[80:95]
    v_mfma_f32_32x32x16_bf16 v[96:111], v[36:39], v[40:43], v[96:111]
    s_add_u32 m0, s54, 24576
    s_add_u32 s55, s53, 1490944
    buffer_load_dwordx4 v11, s[12:15], s55 offen lds
    v_mfma_f32_32x32x16_bf16 v[112:127], v[36:39], v[44:47], v[112:127]
    ds_read_b64_tr_b16 v[32:33], v25 offset:8192
    ds_read_b64_tr_b16 v[34:35], v25 offset:9216
    ds_read_b128 v[40:43], v18
    ds_read_b128 v[44:47], v18 offset:4096
    ds_read_b64_tr_b16 v[36:37], v25 offset:24576
    ds_read_b64_tr_b16 v[38:39], v25 offset:25600
    s_waitcnt lgkmcnt(6)
    v_mfma_f32_32x32x16_bf16 v[64:79], v[48:51], v[56:59], v[64:79]
    s_add_u32 m0, s54, 32768
    s_add_u32 s55, s53, 1376256
    buffer_load_dwordx4 v11, s[16:19], s55 offen lds
    v_mfma_f32_32x32x16_bf16 v[80:95], v[48:51], v[60:63], v[80:95]
    v_mfma_f32_32x32x16_bf16 v[96:111], v[52:55], v[56:59], v[96:111]
    s_add_u32 m0, s54, 40960
    s_add_u32 s55, s53, 1490944
    buffer_load_dwordx4 v11, s[16:19], s55 offen lds
    v_mfma_f32_32x32x16_bf16 v[112:127], v[52:55], v[60:63], v[112:127]
    ds_read_b64_tr_b16 v[48:49], v25 offset:12288
    ds_read_b64_tr_b16 v[50:51], v25 offset:13312
    ds_read_b128 v[56:59], v19
    ds_read_b128 v[60:63], v19 offset:4096
    ds_read_b64_tr_b16 v[52:53], v25 offset:28672
    ds_read_b64_tr_b16 v[54:55], v25 offset:29696
    s_waitcnt lgkmcnt(6)
    v_mfma_f32_32x32x16_bf16 v[64:79], v[32:35], v[40:43], v[64:79]
    v_mfma_f32_32x32x16_bf16 v[80:95], v[32:35], v[44:47], v[80:95]
    v_mfma_f32_32x32x16_bf16 v[96:111], v[36:39], v[40:43], v[96:111]
    v_mfma_f32_32x32x16_bf16 v[112:127], v[36:39], v[44:47], v[112:127]
    s_waitcnt vmcnt(6) lgkmcnt(0)
    s_barrier
    ds_read_b64_tr_b16 v[32:33], v26 offset:0
    ds_read_b64_tr_b16 v[34:35], v26 offset:1024
    ds_read_b128 v[40:43], v20
    ds_read_b128 v[44:47], v20 offset:4096
    ds_read_b64_tr_b16 v[36:37], v26 offset:16384
    ds_read_b64_tr_b16 v[38:39], v26 offset:17408
    v_mfma_f32_32x32x16_bf16 v[64:79], v[48:51], v[56:59], v[64:79]
    s_add_u32 m0, s54, 49152
    s_add_u32 s55, s52, 896
    buffer_load_dwordx4 v10, s[8:11], s55 offen lds
    v_mfma_f32_32x32x16_bf16 v[80:95], v[48:51], v[60:63], v[80:95]
    v_mfma_f32_32x32x16_bf16 v[96:111], v[52:55], v[56:59], v[96:111]
    s_add_u32 m0, s54, 57344
    s_add_u32 s55, s52, 66432
    buffer_load_dwordx4 v10, s[8:11], s55 offen lds
    v_mfma_f32_32x32x16_bf16 v[112:127], v[52:55], v[60:63], v[112:127]
    ds_read_b64_tr_b16 v[48:49], v26 offset:4096
    ds_read_b64_tr_b16 v[50:51], v26 offset:5120
    ds_read_b128 v[56:59], v21
    ds_read_b128 v[60:63], v21 offset:4096
    ds_read_b64_tr_b16 v[52:53], v26 offset:20480
    ds_read_b64_tr_b16 v[54:55], v26 offset:21504
    s_waitcnt lgkmcnt(6)
    v_mfma_f32_32x32x16_bf16 v[64:79], v[32:35], v[40:43], v[64:79]
    s_add_u32 m0, s54, 65536
    s_add_u32 s55, s53, 1605632
    buffer_load_dwordx4 v11, s[12:15], s55 offen lds
    v_mfma_f32_32x32x16_bf16 v[80:95], v[32:35], v[44:47], v[80:95]
    v_mfma_f32_32x32x16_bf16 v[96:111], v[36:39], v[40:43], v[96:111]
    s_add_u32 m0, s54, 73728
    s_add_u32 s55, s53, 1720320
    buffer_load_dwordx4 v11, s[12:15], s55 offen lds
    v_mfma_f32_32x32x16_bf16 v[112:127], v[36:39], v[44:47], v[112:127]
    ds_read_b64_tr_b16 v[32:33], v26 offset:8192
    ds_read_b64_tr_b16 v[34:35], v26 offset:9216
    ds_read_b128 v[40:43], v22
    ds_read_b128 v[44:47], v22 offset:4096
    ds_read_b64_tr_b16 v[36:37], v26 offset:24576
    ds_read_b64_tr_b16 v[38:39], v26 offset:25600
    s_waitcnt lgkmcnt(6)
    v_mfma_f32_32x32x16_bf16 v[64:79], v[48:51], v[56:59], v[64:79]
    s_add_u32 m0, s54, 81920
    s_add_u32 s55, s53, 1605632
    buffer_load_dwordx4 v11, s[16:19], s55 offen lds
    v_mfma_f32_32x32x16_bf16 v[80:95], v[48:51], v[60:63], v[80:95]
    v_mfma_f32_32x32x16_bf16 v[96:111], v[52:55], v[56:59], v[96:111]
    s_add_u32 m0, s54, 90112
    s_add_u32 s55, s53, 1720320
    buffer_load_dwordx4 v11, s[16:19], s55 offen lds
    v_mfma_f32_32x32x16_bf16 v[112:127], v[52:55], v[60:63], v[112:127]
    ds_read_b64_tr_b16 v[48:49], v26 offset:12288
    ds_read_b64_tr_b16 v[50:51], v26 offset:13312
    ds_read_b128 v[56:59], v23
    ds_read_b128 v[60:63], v23 offset:4096
    ds_read_b64_tr_b16 v[52:53], v26 offset:28672
    ds_read_b64_tr_b16 v[54:55], v26 offset:29696
    s_waitcnt lgkmcnt(6)
    v_mfma_f32_32x32x16_bf16 v[64:79], v[32:35], v[40:43], v[64:79]
    v_mfma_f32_32x32x16_bf16 v[80:95], v[32:35], v[44:47], v[80:95]
    v_mfma_f32_32x32x16_bf16 v[96:111], v[36:39], v[40:43], v[96:111]
    v_mfma_f32_32x32x16_bf16 v[112:127], v[36:39], v[44:47], v[112:127]
    s_waitcnt vmcnt(6) lgkmcnt(0)
    s_barrier
    ds_read_b64_tr_b16 v[32:33], v24 offset:0
    ds_read_b64_tr_b16 v[34:35], v24 offset:1024
    ds_read_b128 v[40:43], v12
    ds_read_b128 v[44:47], v12 offset:4096
    ds_read_b64_tr_b16 v[36:37], v24 offset:16384
    ds_read_b64_tr_b16 v[38:39], v24 offset:17408
    v_mfma_f32_32x32x16_bf16 v[64:79], v[48:51], v[56:59], v[64:79]
    v_mfma_f32_32x32x16_bf16 v[80:95], v[48:51], v[60:63], v[80:95]
    v_mfma_f32_32x32x16_bf16 v[96:111], v[52:55], v[56:59], v[96:111]
    v_mfma_f32_32x32x16_bf16 v[112:127], v[52:55], v[60:63], v[112:127]
    ds_read_b64_tr_b16 v[48:49], v24 offset:4096
    ds_read_b64_tr_b16 v[50:51], v24 offset:5120
    ds_read_b128 v[56:59], v13
    ds_read_b128 v[60:63], v13 offset:4096
    ds_read_b64_tr_b16 v[52:53], v24 offset:20480
    ds_read_b64_tr_b16 v[54:55], v24 offset:21504
    s_waitcnt lgkmcnt(6)
    v_mfma_f32_32x32x16_bf16 v[64:79], v[32:35], v[40:43], v[64:79]
    v_mfma_f32_32x32x16_bf16 v[80:95], v[32:35], v[44:47], v[80:95]
    v_mfma_f32_32x32x16_bf16 v[96:111], v[36:39], v[40:43], v[96:111]
    v_mfma_f32_32x32x16_bf16 v[112:127], v[36:39], v[44:47], v[112:127]
    ds_read_b64_tr_b16 v[32:33], v24 offset:8192
    ds_read_b64_tr_b16 v[34:35], v24 offset:9216
    ds_read_b128 v[40:43], v14
    ds_read_b128 v[44:47], v14 offset:4096
    ds_read_b64_tr_b16 v[36:37], v24 offset:24576
    ds_read_b64_tr_b16 v[38:39], v24 offset:25600
    s_waitcnt lgkmcnt(6)
    v_mfma_f32_32x32x16_bf16 v[64:79], v[48:51], v[56:59], v[64:79]
    v_mfma_f32_32x32x16_bf16 v[80:95], v[48:51], v[60:63], v[80:95]
    v_mfma_f32_32x32x16_bf16 v[96:111], v[52:55], v[56:59], v[96:111]
    v_mfma_f32_32x32x16_bf16 v[112:127], v[52:55], v[60:63], v[112:127]
    ds_read_b64_tr_b16 v[48:49], v24 offset:12288
    ds_read_b64_tr_b16 v[50:51], v24 offset:13312
    ds_read_b128 v[56:59], v15
    ds_read_b128 v[60:63], v15 offset:4096
    ds_read_b64_tr_b16 v[52:53], v24 offset:28672
    ds_read_b64_tr_b16 v[54:55], v24 offset:29696
    s_waitcnt lgkmcnt(6)
    v_mfma_f32_32x32x16_bf16 v[64:79], v[32:35], v[40:43], v[64:79]
    v_mfma_f32_32x32x16_bf16 v[80:95], v[32:35], v[44:47], v[80:95]
    v_mfma_f32_32x32x16_bf16 v[96:111], v[36:39], v[40:43], v[96:111]
    v_mfma_f32_32x32x16_bf16 v[112:127], v[36:39], v[44:47], v[112:127]
    s_waitcnt vmcnt(0) lgkmcnt(0)
    s_barrier
    ds_read_b64_tr_b16 v[32:33], v25 offset:0
    ds_read_b64_tr_b16 v[34:35], v25 offset:1024
    ds_read_b128 v[40:43], v16
    ds_read_b128 v[44:47], v16 offset:4096
    ds_read_b64_tr_b16 v[36:37], v25 offset:16384
    ds_read_b64_tr_b16 v[38:39], v25 offset:17408
    v_mfma_f32_32x32x16_bf16 v[64:79], v[48:51], v[56:59], v[64:79]
    v_mfma_f32_32x32x16_bf16 v[80:95], v[48:51], v[60:63], v[80:95]
    v_mfma_f32_32x32x16_bf16 v[96:111], v[52:55], v[56:59], v[96:111]
    v_mfma_f32_32x32x16_bf16 v[112:127], v[52:55], v[60:63], v[112:127]
    ds_read_b64_tr_b16 v[48:49], v25 offset:4096
    ds_read_b64_tr_b16 v[50:51], v25 offset:5120
    ds_read_b128 v[56:59], v17
    ds_read_b128 v[60:63], v17 offset:4096
    ds_read_b64_tr_b16 v[52:53], v25 offset:20480
    ds_read_b64_tr_b16 v[54:55], v25 offset:21504
    s_waitcnt lgkmcnt(6)
    v_mfma_f32_32x32x16_bf16 v[64:79], v[32:35], v[40:43], v[64:79]
    v_mfma_f32_32x32x16_bf16 v[80:95], v[32:35], v[44:47], v[80:95]
    v_mfma_f32_32x32x16_bf16 v[96:111], v[36:39], v[40:43], v[96:111]
    v_mfma_f32_32x32x16_bf16 v[112:127], v[36:39], v[44:47], v[112:127]
    ds_read_b64_tr_b16 v[32:33], v25 offset:8192
    ds_read_b64_tr_b16 v[34:35], v25 offset:9216
    ds_read_b128 v[40:43], v18
    ds_read_b128 v[44:47], v18 offset:4096
    ds_read_b64_tr_b16 v[36:37], v25 offset:24576
    ds_read_b64_tr_b16 v[38:39], v25 offset:25600
    s_waitcnt lgkmcnt(6)
    v_mfma_f32_32x32x16_bf16 v[64:79], v[48:51], v[56:59], v[64:79]
    v_mfma_f32_32x32x16_bf16 v[80:95], v[48:51], v[60:63], v[80:95]
    v_mfma_f32_32x32x16_bf16 v[96:111], v[52:55], v[56:59], v[96:111]
    v_mfma_f32_32x32x16_bf16 v[112:127], v[52:55], v[60:63], v[112:127]
    ds_read_b64_tr_b16 v[48:49], v25 offset:12288
    ds_read_b64_tr_b16 v[50:51], v25 offset:13312
    ds_read_b128 v[56:59], v19
    ds_read_b128 v[60:63], v19 offset:4096
    ds_read_b64_tr_b16 v[52:53], v25 offset:28672
    ds_read_b64_tr_b16 v[54:55], v25 offset:29696
    s_waitcnt lgkmcnt(6)
    v_mfma_f32_32x32x16_bf16 v[64:79], v[32:35], v[40:43], v[64:79]
    v_mfma_f32_32x32x16_bf16 v[80:95], v[32:35], v[44:47], v[80:95]
    v_mfma_f32_32x32x16_bf16 v[96:111], v[36:39], v[40:43], v[96:111]
    v_mfma_f32_32x32x16_bf16 v[112:127], v[36:39], v[44:47], v[112:127]
    s_waitcnt lgkmcnt(0)
    v_mfma_f32_32x32x16_bf16 v[64:79], v[48:51], v[56:59], v[64:79]
    v_mfma_f32_32x32x16_bf16 v[80:95], v[48:51], v[60:63], v[80:95]
    v_mfma_f32_32x32x16_bf16 v[96:111], v[52:55], v[56:59], v[96:111]
    v_mfma_f32_32x32x16_bf16 v[112:127], v[52:55], v[60:63], v[112:127]
    v_mov_b32 v2, 0xc0135761
    v_mov_b32 v3, v2
    v_mov_b32 v4, 0xbdd2d3e8
    v_mov_b32 v5, v4
    v_mov_b32 v6, 1.0
    v_mov_b32 v7, 1.0
    s_mul_i32 s51, s48, 5120
    s_add_u32 s51, s51, 98304
    v_and_b32 v8, 31, v0
    v_mul_u32_u24 v8, 80, v8
    v_bfe_u32 v9, v0, 5, 1
    v_lshl_add_u32 v8, v9, 3, v8
    v_add_u32 v8, s51, v8
    v_and_b32 v9, 63, v0
    v_lshrrev_b32 v10, 2, v9
    v_and_b32 v9, 3, v9
    v_mul_u32_u24 v11, 80, v10
    v_lshl_add_u32 v11, v9, 4, v11
    v_add_u32 v11, s51, v11
    v_lshlrev_b32 v10, 8, v10
    v_lshl_add_u32 v10, v9, 4, v10
    s_lshl_b32 s51, s49, 1
    s_add_u32 s51, s51, s57
    s_mul_i32 s51, s51, 14
    s_add_u32 s51, s51, s50
    s_lshl_b32 s51, s51, 14
    s_lshl_b32 s55, s56, 6
    s_add_u32 s51, s51, s55
    s_nop 4
    v_pk_mul_f32 v[32:33], v[64:65], v[64:65]
    v_pk_mul_f32 v[34:35], v[66:67], v[66:67]
    v_pk_mul_f32 v[36:37], v[68:69], v[68:69]
    v_pk_mul_f32 v[38:39], v[70:71], v[70:71]
    v_pk_fma_f32 v[32:33], v[32:33], v[4:5], v[2:3]
    v_pk_fma_f32 v[34:35], v[34:35], v[4:5], v[2:3]
    v_pk_fma_f32 v[36:37], v[36:37], v[4:5], v[2:3]
    v_pk_fma_f32 v[38:39], v[38:39], v[4:5], v[2:3]
    v_pk_mul_f32 v[32:33], v[32:33], v[64:65]
    v_pk_mul_f32 v[34:35], v[34:35], v[66:67]
    v_pk_mul_f32 v[36:37], v[36:37], v[68:69]
    v_pk_mul_f32 v[38:39], v[38:39], v[70:71]
    v_exp_f32 v32, v32
    v_exp_f32 v33, v33
    v_exp_f32 v34, v34
    v_exp_f32 v35, v35
    v_exp_f32 v36, v36
    v_exp_f32 v37, v37
    v_exp_f32 v38, v38
    v_exp_f32 v39, v39
    v_pk_mul_f32 v[64:65], v[64:65], v[96:97]
    v_pk_mul_f32 v[66:67], v[66:67], v[98:99]
    v_pk_mul_f32 v[68:69], v[68:69], v[100:101]
    v_pk_mul_f32 v[70:71], v[70:71], v[102:103]
    v_pk_add_f32 v[32:33], v[32:33], v[6:7]
    v_pk_add_f32 v[34:35], v[34:35], v[6:7]
    v_pk_add_f32 v[36:37], v[36:37], v[6:7]
    v_pk_add_f32 v[38:39], v[38:39], v[6:7]
    v_rcp_f32 v32, v32
    v_rcp_f32 v33, v33
    v_rcp_f32 v34, v34
    v_rcp_f32 v35, v35
    v_rcp_f32 v36, v36
    v_rcp_f32 v37, v37
    v_rcp_f32 v38, v38
    v_rcp_f32 v39, v39
    s_nop 0
    v_pk_mul_f32 v[64:65], v[64:65], v[32:33]
    v_pk_mul_f32 v[66:67], v[66:67], v[34:35]
    v_pk_mul_f32 v[68:69], v[68:69], v[36:37]
    v_pk_mul_f32 v[70:71], v[70:71], v[38:39]
    v_cvt_pk_bf16_f32 v40, v64, v65
    v_cvt_pk_bf16_f32 v41, v66, v67
    v_cvt_pk_bf16_f32 v42, v68, v69
    v_cvt_pk_bf16_f32 v43, v70, v71
    ds_write_b64 v8, v[40:41] offset:0
    ds_write_b64 v8, v[42:43] offset:16
    v_pk_mul_f32 v[48:49], v[72:73], v[72:73]
    v_pk_mul_f32 v[50:51], v[74:75], v[74:75]
    v_pk_mul_f32 v[52:53], v[76:77], v[76:77]
    v_pk_mul_f32 v[54:55], v[78:79], v[78:79]
    v_pk_fma_f32 v[48:49], v[48:49], v[4:5], v[2:3]
    v_pk_fma_f32 v[50:51], v[50:51], v[4:5], v[2:3]
    v_pk_fma_f32 v[52:53], v[52:53], v[4:5], v[2:3]
    v_pk_fma_f32 v[54:55], v[54:55], v[4:5], v[2:3]
    v_pk_mul_f32 v[48:49], v[48:49], v[72:73]
    v_pk_mul_f32 v[50:51], v[50:51], v[74:75]
    v_pk_mul_f32 v[52:53], v[52:53], v[76:77]
    v_pk_mul_f32 v[54:55], v[54:55], v[78:79]
    v_exp_f32 v48, v48
    v_exp_f32 v49, v49
    v_exp_f32 v50, v50
    v_exp_f32 v51, v51
    v_exp_f32 v52, v52
    v_exp_f32 v53, v53
    v_exp_f32 v54, v54
    v_exp_f32 v55, v55
    v_pk_mul_f32 v[72:73], v[72:73], v[104:105]
    v_pk_mul_f32 v[74:75], v[74:75], v[106:107]
    v_pk_mul_f32 v[76:77], v[76:77], v[108:109]
    v_pk_mul_f32 v[78:79], v[78:79], v[110:111]
    v_pk_add_f32 v[48:49], v[48:49], v[6:7]
    v_pk_add_f32 v[50:51], v[50:51], v[6:7]
    v_pk_add_f32 v[52:53], v[52:53], v[6:7]
    v_pk_add_f32 v[54:55], v[54:55], v[6:7]
    v_rcp_f32 v48, v48
    v_rcp_f32 v49, v49
    v_rcp_f32 v50, v50
    v_rcp_f32 v51, v51
    v_rcp_f32 v52, v52
    v_rcp_f32 v53, v53
    v_rcp_f32 v54, v54
    v_rcp_f32 v55, v55
    s_nop 0
    v_pk_mul_f32 v[72:73], v[72:73], v[48:49]
    v_pk_mul_f32 v[74:75], v[74:75], v[50:51]
    v_pk_mul_f32 v[76:77], v[76:77], v[52:53]
    v_pk_mul_f32 v[78:79], v[78:79], v[54:55]
    v_cvt_pk_bf16_f32 v56, v72, v73
    v_cvt_pk_bf16_f32 v57, v74, v75
    v_cvt_pk_bf16_f32 v58, v76, v77
    v_cvt_pk_bf16_f32 v59, v78, v79
    ds_write_b64 v8, v[56:57] offset:32
    ds_write_b64 v8, v[58:59] offset:48
    s_waitcnt lgkmcnt(0)
    ds_read_b128 v[16:19], v11 offset:0
    ds_read_b128 v[20:23], v11 offset:1280
    s_waitcnt lgkmcnt(0)
    s_add_u32 s55, s51, 0
    buffer_store_dwordx4 v[16:19], v10, s[20:23], s55 offen sc1
    s_add_u32 s55, s51, 4096
    buffer_store_dwordx4 v[20:23], v10, s[20:23], s55 offen sc1
    v_pk_mul_f32 v[32:33], v[80:81], v[80:81]
    v_pk_mul_f32 v[34:35], v[82:83], v[82:83]
    v_pk_mul_f32 v[36:37], v[84:85], v[84:85]
    v_pk_mul_f32 v[38:39], v[86:87], v[86:87]
    v_pk_fma_f32 v[32:33], v[32:33], v[4:5], v[2:3]
    v_pk_fma_f32 v[34:35], v[34:35], v[4:5], v[2:3]
    v_pk_fma_f32 v[36:37], v[36:37], v[4:5], v[2:3]
    v_pk_fma_f32 v[38:39], v[38:39], v[4:5], v[2:3]
    v_pk_mul_f32 v[32:33], v[32:33], v[80:81]
    v_pk_mul_f32 v[34:35], v[34:35], v[82:83]
    v_pk_mul_f32 v[36:37], v[36:37], v[84:85]
    v_pk_mul_f32 v[38:39], v[38:39], v[86:87]
    v_exp_f32 v32, v32
    v_exp_f32 v33, v33
    v_exp_f32 v34, v34
    v_exp_f32 v35, v35
    v_exp_f32 v36, v36
    v_exp_f32 v37, v37
    v_exp_f32 v38, v38
    v_exp_f32 v39, v39
    v_pk_mul_f32 v[80:81], v[80:81], v[112:113]
    v_pk_mul_f32 v[82:83], v[82:83], v[114:115]
    v_pk_mul_f32 v[84:85], v[84:85], v[116:117]
    v_pk_mul_f32 v[86:87], v[86:87], v[118:119]
    v_pk_add_f32 v[32:33], v[32:33], v[6:7]
    v_pk_add_f32 v[34:35], v[34:35], v[6:7]
    v_pk_add_f32 v[36:37], v[36:37], v[6:7]
    v_pk_add_f32 v[38:39], v[38:39], v[6:7]
    v_rcp_f32 v32, v32
    v_rcp_f32 v33, v33
    v_rcp_f32 v34, v34
    v_rcp_f32 v35, v35
    v_rcp_f32 v36, v36
    v_rcp_f32 v37, v37
    v_rcp_f32 v38, v38
    v_rcp_f32 v39, v39
    s_nop 0
    v_pk_mul_f32 v[80:81], v[80:81], v[32:33]
    v_pk_mul_f32 v[82:83], v[82:83], v[34:35]
    v_pk_mul_f32 v[84:85], v[84:85], v[36:37]
    v_pk_mul_f32 v[86:87], v[86:87], v[38:39]
    v_cvt_pk_bf16_f32 v40, v80, v81
    v_cvt_pk_bf16_f32 v41, v82, v83
    v_cvt_pk_bf16_f32 v42, v84, v85
    v_cvt_pk_bf16_f32 v43, v86, v87
    ds_write_b64 v8, v[40:41] offset:2560
    ds_write_b64 v8, v[42:43] offset:2576
    v_pk_mul_f32 v[48:49], v[88:89], v[88:89]
    v_pk_mul_f32 v[50:51], v[90:91], v[90:91]
    v_pk_mul_f32 v[52:53], v[92:93], v[92:93]
    v_pk_mul_f32 v[54:55], v[94:95], v[94:95]
    v_pk_fma_f32 v[48:49], v[48:49], v[4:5], v[2:3]
    v_pk_fma_f32 v[50:51], v[50:51], v[4:5], v[2:3]
    v_pk_fma_f32 v[52:53], v[52:53], v[4:5], v[2:3]
    v_pk_fma_f32 v[54:55], v[54:55], v[4:5], v[2:3]
    v_pk_mul_f32 v[48:49], v[48:49], v[88:89]
    v_pk_mul_f32 v[50:51], v[50:51], v[90:91]
    v_pk_mul_f32 v[52:53], v[52:53], v[92:93]
    v_pk_mul_f32 v[54:55], v[54:55], v[94:95]
    v_exp_f32 v48, v48
    v_exp_f32 v49, v49
    v_exp_f32 v50, v50
    v_exp_f32 v51, v51
    v_exp_f32 v52, v52
    v_exp_f32 v53, v53
    v_exp_f32 v54, v54
    v_exp_f32 v55, v55
    v_pk_mul_f32 v[88:89], v[88:89], v[120:121]
    v_pk_mul_f32 v[90:91], v[90:91], v[122:123]
    v_pk_mul_f32 v[92:93], v[92:93], v[124:125]
    v_pk_mul_f32 v[94:95], v[94:95], v[126:127]
    v_pk_add_f32 v[48:49], v[48:49], v[6:7]
    v_pk_add_f32 v[50:51], v[50:51], v[6:7]
    v_pk_add_f32 v[52:53], v[52:53], v[6:7]
    v_pk_add_f32 v[54:55], v[54:55], v[6:7]
    v_rcp_f32 v48, v48
    v_rcp_f32 v49, v49
    v_rcp_f32 v50, v50
    v_rcp_f32 v51, v51
    v_rcp_f32 v52, v52
    v_rcp_f32 v53, v53
    v_rcp_f32 v54, v54
    v_rcp_f32 v55, v55
    s_nop 0
    v_pk_mul_f32 v[88:89], v[88:89], v[48:49]
    v_pk_mul_f32 v[90:91], v[90:91], v[50:51]
    v_pk_mul_f32 v[92:93], v[92:93], v[52:53]
    v_pk_mul_f32 v[94:95], v[94:95], v[54:55]
    v_cvt_pk_bf16_f32 v56, v88, v89
    v_cvt_pk_bf16_f32 v57, v90, v91
    v_cvt_pk_bf16_f32 v58, v92, v93
    v_cvt_pk_bf16_f32 v59, v94, v95
    ds_write_b64 v8, v[56:57] offset:2592
    ds_write_b64 v8, v[58:59] offset:2608
    s_waitcnt lgkmcnt(0)
    ds_read_b128 v[24:27], v11 offset:2560
    ds_read_b128 v[28:31], v11 offset:3840
    s_waitcnt lgkmcnt(0)
    s_add_u32 s55, s51, 8192
    buffer_store_dwordx4 v[24:27], v10, s[20:23], s55 offen sc1
    s_add_u32 s55, s51, 12288
    buffer_store_dwordx4 v[28:31], v10, s[20:23], s55 offen sc1
    s_endpgm
L_g1_cp_202:
    s_load_dwordx2 s[16:17], s[0:1], 64
    s_sub_u32 s20, s2, 224
    s_lshl_b32 s20, s20, 2
    v_lshlrev_b32 v1, 4, v0
    v_and_b32 v2, 63, v0
    v_lshrrev_b32 v2, 3, v2
    v_mul_u32_u24 v2, 229376, v2
    v_lshrrev_b32 v3, 6, v0
    v_lshl_add_u32 v2, v3, 7, v2
    v_and_b32 v3, 7, v0
    v_lshl_add_u32 v2, v3, 4, v2
    s_mul_i32 s21, s20, 14336
    s_mul_i32 s22, s20, 1792
    s_waitcnt lgkmcnt(0)
    s_mov_b32 s18, 1835008
    s_mov_b32 s19, 0x00020000
    s_add_u32 s24, s44, 18874368
    s_addc_u32 s25, s45, 0
    s_mov_b32 s26, 1835008
    s_mov_b32 s27, 0x00020000
    s_add_u32 s32, s21, 0
    s_add_u32 s36, s21, 8192
    s_add_u32 s48, s22, 0
    s_add_u32 s52, s22, 1024
    s_add_u32 s33, s21, 14336
    s_add_u32 s37, s21, 22528
    s_add_u32 s49, s22, 1792
    s_add_u32 s53, s22, 2816
    s_add_u32 s34, s21, 28672
    s_add_u32 s38, s21, 36864
    s_add_u32 s50, s22, 3584
    s_add_u32 s54, s22, 4608
    s_add_u32 s35, s21, 43008
    s_add_u32 s39, s21, 51200
    s_add_u32 s51, s22, 5376
    s_add_u32 s55, s22, 6400
    buffer_load_dwordx4 v[4:7], v1, s[16:19], s32 offen
    buffer_load_dwordx4 v[8:11], v1, s[16:19], s33 offen
    buffer_load_dwordx4 v[12:15], v1, s[16:19], s34 offen
    buffer_load_dwordx4 v[16:19], v1, s[16:19], s35 offen
    v_cmp_gt_u32 vcc, 384, v0
    s_and_saveexec_b64 s[30:31], vcc
    s_cbranch_execz L_g1_wl_203
    buffer_load_dwordx4 v[20:23], v1, s[16:19], s36 offen
    buffer_load_dwordx4 v[24:27], v1, s[16:19], s37 offen
    buffer_load_dwordx4 v[28:31], v1, s[16:19], s38 offen
    buffer_load_dwordx4 v[32:35], v1, s[16:19], s39 offen
    s_waitcnt vmcnt(0)
    buffer_store_dwordx4 v[20:23], v2, s[24:27], s52 offen sc1
    buffer_store_dwordx4 v[24:27], v2, s[24:27], s53 offen sc1
    buffer_store_dwordx4 v[28:31], v2, s[24:27], s54 offen sc1
    buffer_store_dwordx4 v[32:35], v2, s[24:27], s55 offen sc1
L_g1_wl_203:
    s_mov_b64 exec, s[30:31]
    s_waitcnt vmcnt(0)
    buffer_store_dwordx4 v[4:7], v2, s[24:27], s48 offen sc1
    buffer_store_dwordx4 v[8:11], v2, s[24:27], s49 offen sc1
    buffer_store_dwordx4 v[12:15], v2, s[24:27], s50 offen sc1
    buffer_store_dwordx4 v[16:19], v2, s[24:27], s51 offen sc1
    s_waitcnt vmcnt(0)
L_g1_done_201:
    s_endpgm
.globl g20_kernel
.p2align 8
.type g20_kernel,@function
g20_kernel:
    s_load_dwordx2 s[4:5], s[0:1], 64
    s_load_dwordx2 s[6:7], s[0:1], 72
    s_load_dwordx2 s[44:45], s[0:1], 88
    s_cmp_ge_u32 s2, 256
    s_cbranch_scc1 L_g2_done_301
    s_and_b32 s46, s2, 7
    s_lshr_b32 s47, s2, 3
    s_lshl_b32 s49, s46, 2
    s_and_b32 s50, s47, 3
    s_add_u32 s49, s49, s50
    s_lshr_b32 s50, s47, 2
    v_lshrrev_b32 v1, 6, v0
    v_and_b32 v2, 63, v0
    v_readfirstlane_b32 s48, v1
    v_lshrrev_b32 v4, 4, v2
    s_lshl_b32 s51, s48, 2
    v_add_u32 v3, s51, v4
    v_and_b32 v5, 15, v3
    v_and_b32 v6, 15, v2
    v_xor_b32 v5, v5, v6
    v_mul_u32_u24 v3, 256, v3
    v_lshl_add_u32 v10, v5, 4, v3
    v_lshrrev_b32 v3, 3, v2
    s_lshl_b32 s51, s48, 3
    v_add_u32 v3, s51, v3
    v_bfe_u32 v5, v3, 1, 1
    v_lshlrev_b32 v5, 2, v5
    v_and_b32 v6, 7, v2
    v_xor_b32 v5, v5, v6
    v_lshlrev_b32 v3, 7, v3
    v_lshl_add_u32 v11, v5, 4, v3
    s_mul_i32 s52, s49, 229376
    s_lshl_b32 s53, s50, 7
    s_lshl_b32 s54, s48, 10
    s_mul_i32 s60, s50, 229376
    s_waitcnt lgkmcnt(0)
    s_add_u32 s8, s44, 6291456
    s_addc_u32 s9, s45, 0
    s_mov_b32 s10, 7340032
    s_mov_b32 s11, 0x00020000
    s_add_u32 s12, s44, 18874368
    s_addc_u32 s13, s45, 0
    s_mov_b32 s14, 1835008
    s_mov_b32 s15, 0x00020000
    s_add_u32 m0, s54, 0
    s_add_u32 s55, s52, 0
    buffer_load_dwordx4 v10, s[8:11], s55 offen lds
    s_add_u32 m0, s54, 8192
    s_add_u32 s55, s52, 8192
    buffer_load_dwordx4 v10, s[8:11], s55 offen lds
    s_add_u32 m0, s54, 16384
    s_add_u32 s55, s60, 0
    buffer_load_dwordx4 v11, s[12:15], s55 offen lds
    s_add_u32 m0, s54, 24576
    s_add_u32 s55, s60, 8192
    buffer_load_dwordx4 v11, s[12:15], s55 offen lds
    s_add_u32 m0, s54, 32768
    s_add_u32 s55, s52, 16384
    buffer_load_dwordx4 v10, s[8:11], s55 offen lds
    s_add_u32 s16, s44, 2097152
    s_addc_u32 s17, s45, 0
    s_mov_b32 s18, 2097152
    s_mov_b32 s19, 0x00020000
    s_add_u32 m0, s54, 40960
    s_add_u32 s55, s52, 24576
    buffer_load_dwordx4 v10, s[8:11], s55 offen lds
    s_add_u32 s20, s44, 14680064
    s_addc_u32 s21, s45, 0
    s_mov_b32 s22, 2097152
    s_mov_b32 s23, 0x00020000
    s_add_u32 m0, s54, 49152
    s_add_u32 s55, s60, 16384
    buffer_load_dwordx4 v11, s[12:15], s55 offen lds
    s_and_b32 s56, s48, 1
    s_bfe_u32 s57, s48, 0x10001
    s_lshr_b32 s58, s48, 2
    v_and_b32 v3, 31, v2
    s_add_u32 m0, s54, 57344
    s_add_u32 s55, s60, 24576
    buffer_load_dwordx4 v11, s[12:15], s55 offen lds
    v_lshrrev_b32 v4, 5, v2
    s_lshl_b32 s51, s57, 5
    v_add_u32 v5, s51, v3
    v_and_b32 v6, 15, v5
    v_lshlrev_b32 v5, 8, v5
    s_add_u32 m0, s54, 65536
    s_add_u32 s55, s52, 32768
    buffer_load_dwordx4 v10, s[8:11], s55 offen lds
    s_lshl_b32 s51, s58, 3
    v_add_u32 v8, s51, v4
    v_add_u32 v7, 0, v8
    v_xor_b32 v7, v7, v6
    s_add_u32 m0, s54, 73728
    s_add_u32 s55, s52, 40960
    buffer_load_dwordx4 v10, s[8:11], s55 offen lds
    v_lshl_add_u32 v12, v7, 4, v5
    v_add_u32 v16, 65536, v12
    v_add_u32 v20, 131072, v12
    v_add_u32 v7, 2, v8
    s_add_u32 m0, s54, 81920
    s_add_u32 s55, s60, 32768
    buffer_load_dwordx4 v11, s[12:15], s55 offen lds
    v_xor_b32 v7, v7, v6
    v_lshl_add_u32 v13, v7, 4, v5
    v_add_u32 v17, 65536, v13
    v_add_u32 v21, 131072, v13
    s_add_u32 m0, s54, 90112
    s_add_u32 s55, s60, 40960
    buffer_load_dwordx4 v11, s[12:15], s55 offen lds
    v_add_u32 v7, 4, v8
    v_xor_b32 v7, v7, v6
    v_lshl_add_u32 v14, v7, 4, v5
    v_add_u32 v18, 65536, v14
    v_add_u32 v22, 131072, v14
    s_add_u32 m0, s54, 98304
    s_add_u32 s55, s52, 49152
    buffer_load_dwordx4 v10, s[8:11], s55 offen lds
    v_add_u32 v7, 6, v8
    v_xor_b32 v7, v7, v6
    v_lshl_add_u32 v15, v7, 4, v5
    v_add_u32 v19, 65536, v15
    s_add_u32 m0, s54, 106496
    s_add_u32 s55, s52, 57344
    buffer_load_dwordx4 v10, s[8:11], s55 offen lds
    v_add_u32 v23, 131072, v15
    v_and_b32 v5, 15, v2
    v_lshrrev_b32 v5, 2, v5
    v_lshl_add_u32 v6, v4, 3, v5
    s_add_u32 m0, s54, 114688
    s_add_u32 s55, s60, 49152
    buffer_load_dwordx4 v11, s[12:15], s55 offen lds
    s_lshl_b32 s51, s58, 6
    v_add_u32 v6, s51, v6
    v_lshlrev_b32 v6, 7, v6
    v_bfe_u32 v7, v5, 1, 1
    s_add_u32 m0, s54, 122880
    s_add_u32 s55, s60, 57344
    buffer_load_dwordx4 v11, s[12:15], s55 offen lds
    v_xor_b32 v7, s56, v7
    v_lshlrev_b32 v7, 2, v7
    v_bfe_u32 v8, v2, 4, 1
    v_lshl_add_u32 v7, v8, 1, v7
    v_bfe_u32 v8, v2, 1, 1
    s_add_u32 m0, s54, 131072
    s_add_u32 s55, s52, 65536
    buffer_load_dwordx4 v10, s[8:11], s55 offen lds
    v_add_u32 v7, v7, v8
    v_lshl_add_u32 v6, v7, 4, v6
    v_and_b32 v8, 1, v2
    v_lshl_add_u32 v6, v8, 3, v6
    s_add_u32 m0, s54, 139264
    s_add_u32 s55, s52, 73728
    buffer_load_dwordx4 v10, s[8:11], s55 offen lds
    v_add_u32 v28, 16384, v6
    v_add_u32 v29, 65536, v28
    v_add_u32 v30, 131072, v28
    v_lshrrev_b32 v5, 3, v2
    s_add_u32 m0, s54, 147456
    s_add_u32 s55, s60, 65536
    buffer_load_dwordx4 v11, s[12:15], s55 offen lds
    s_lshl_b32 s51, s48, 3
    v_add_u32 v5, s51, v5
    v_and_b32 v6, 7, v2
    v_lshlrev_b32 v6, 4, v6
    s_add_u32 m0, s54, 155648
    s_add_u32 s55, s60, 73728
    buffer_load_dwordx4 v11, s[12:15], s55 offen lds
    s_lshl_b32 s51, s49, 6
    v_add_u32 v7, s51, v5
    v_lshl_add_u32 v80, v7, 10, v6
    v_mov_b32 v81, v80
    s_mov_b32 s59, s53
    s_waitcnt vmcnt(16)
    s_barrier
    ds_read_b64_tr_b16 v[32:33], v28 offset:0
    ds_read_b64_tr_b16 v[34:35], v28 offset:512
    ds_read_b128 v[36:39], v12 offset:0
    ds_read_b64_tr_b16 v[40:41], v28 offset:2048
    ds_read_b64_tr_b16 v[42:43], v28 offset:2560
    ds_read_b128 v[44:47], v13 offset:0
    ds_read_b64_tr_b16 v[48:49], v28 offset:4096
    ds_read_b64_tr_b16 v[50:51], v28 offset:4608
    ds_read_b128 v[52:55], v14 offset:0
    ds_read_b64_tr_b16 v[56:57], v28 offset:6144
    ds_read_b64_tr_b16 v[58:59], v28 offset:6656
    ds_read_b128 v[60:63], v15 offset:0
    s_waitcnt lgkmcnt(9)
    v_mfma_f32_32x32x16_bf16 v[64:79], v[32:35], v[36:39], 0
    s_waitcnt lgkmcnt(6)
    v_mfma_f32_32x32x16_bf16 v[64:79], v[40:43], v[44:47], v[64:79]
    s_waitcnt lgkmcnt(3)
    v_mfma_f32_32x32x16_bf16 v[64:79], v[48:51], v[52:55], v[64:79]
    s_waitcnt lgkmcnt(0)
    v_mfma_f32_32x32x16_bf16 v[64:79], v[56:59], v[60:63], v[64:79]
    s_waitcnt vmcnt(12)
    s_barrier
    ds_read_b64_tr_b16 v[32:33], v28 offset:32768
    ds_read_b64_tr_b16 v[34:35], v28 offset:33280
    ds_read_b128 v[36:39], v12 offset:32768
    ds_read_b64_tr_b16 v[40:41], v28 offset:34816
    ds_read_b64_tr_b16 v[42:43], v28 offset:35328
    ds_read_b128 v[44:47], v13 offset:32768
    ds_read_b64_tr_b16 v[48:49], v28 offset:36864
    ds_read_b64_tr_b16 v[50:51], v28 offset:37376
    ds_read_b128 v[52:55], v14 offset:32768
    ds_read_b64_tr_b16 v[56:57], v28 offset:38912
    ds_read_b64_tr_b16 v[58:59], v28 offset:39424
    ds_read_b128 v[60:63], v15 offset:32768
    s_add_u32 m0, s54, 0
    s_add_u32 s55, s52, 81920
    buffer_load_dwordx4 v10, s[8:11], s55 offen lds
    s_waitcnt lgkmcnt(9)
    v_mfma_f32_32x32x16_bf16 v[64:79], v[32:35], v[36:39], v[64:79]
    s_add_u32 m0, s54, 8192
    s_add_u32 s55, s52, 90112
    buffer_load_dwordx4 v10, s[8:11], s55 offen lds
    s_waitcnt lgkmcnt(6)
    v_mfma_f32_32x32x16_bf16 v[64:79], v[40:43], v[44:47], v[64:79]
    s_add_u32 m0, s54, 16384
    s_add_u32 s55, s60, 81920
    buffer_load_dwordx4 v11, s[12:15], s55 offen lds
    s_waitcnt lgkmcnt(3)
    v_mfma_f32_32x32x16_bf16 v[64:79], v[48:51], v[52:55], v[64:79]
    s_add_u32 m0, s54, 24576
    s_add_u32 s55, s60, 90112
    buffer_load_dwordx4 v11, s[12:15], s55 offen lds
    s_waitcnt lgkmcnt(0)
    v_mfma_f32_32x32x16_bf16 v[64:79], v[56:59], v[60:63], v[64:79]
    s_waitcnt vmcnt(12)
    s_barrier
    ds_read_b64_tr_b16 v[32:33], v29 offset:0
    ds_read_b64_tr_b16 v[34:35], v29 offset:512
    ds_read_b128 v[36:39], v16 offset:0
    ds_read_b64_tr_b16 v[40:41], v29 offset:2048
    ds_read_b64_tr_b16 v[42:43], v29 offset:2560
    ds_read_b128 v[44:47], v17 offset:0
    ds_read_b64_tr_b16 v[48:49], v29 offset:4096
    ds_read_b64_tr_b16 v[50:51], v29 offset:4608
    ds_read_b128 v[52:55], v18 offset:0
    ds_read_b64_tr_b16 v[56:57], v29 offset:6144
    ds_read_b64_tr_b16 v[58:59], v29 offset:6656
    ds_read_b128 v[60:63], v19 offset:0
    s_add_u32 m0, s54, 32768
    s_add_u32 s55, s52, 98304
    buffer_load_dwordx4 v10, s[8:11], s55 offen lds
    s_waitcnt lgkmcnt(9)
    v_mfma_f32_32x32x16_bf16 v[64:79], v[32:35], v[36:39], v[64:79]
    s_add_u32 m0, s54, 40960
    s_add_u32 s55, s52, 106496
    buffer_load_dwordx4 v10, s[8:11], s55 offen lds
    s_waitcnt lgkmcnt(6)
    v_mfma_f32_32x32x16_bf16 v[64:79], v[40:43], v[44:47], v[64:79]
    s_add_u32 m0, s54, 49152
    s_add_u32 s55, s60, 98304
    buffer_load_dwordx4 v11, s[12:15], s55 offen lds
    s_waitcnt lgkmcnt(3)
    v_mfma_f32_32x32x16_bf16 v[64:79], v[48:51], v[52:55], v[64:79]
    s_add_u32 m0, s54, 57344
    s_add_u32 s55, s60, 106496
    buffer_load_dwordx4 v11, s[12:15], s55 offen lds
    s_waitcnt lgkmcnt(0)
    v_mfma_f32_32x32x16_bf16 v[64:79], v[56:59], v[60:63], v[64:79]
    s_waitcnt vmcnt(12)
    s_barrier
    ds_read_b64_tr_b16 v[32:33], v29 offset:32768
    ds_read_b64_tr_b16 v[34:35], v29 offset:33280
    ds_read_b128 v[36:39], v16 offset:32768
    ds_read_b64_tr_b16 v[40:41], v29 offset:34816
    ds_read_b64_tr_b16 v[42:43], v29 offset:35328
    ds_read_b128 v[44:47], v17 offset:32768
    ds_read_b64_tr_b16 v[48:49], v29 offset:36864
    ds_read_b64_tr_b16 v[50:51], v29 offset:37376
    ds_read_b128 v[52:55], v18 offset:32768
    ds_read_b64_tr_b16 v[56:57], v29 offset:38912
    ds_read_b64_tr_b16 v[58:59], v29 offset:39424
    ds_read_b128 v[60:63], v19 offset:32768
    s_add_u32 m0, s54, 65536
    s_add_u32 s55, s52, 114688
    buffer_load_dwordx4 v10, s[8:11], s55 offen lds
    s_waitcnt lgkmcnt(9)
    v_mfma_f32_32x32x16_bf16 v[64:79], v[32:35], v[36:39], v[64:79]
    s_add_u32 m0, s54, 73728
    s_add_u32 s55, s52, 122880
    buffer_load_dwordx4 v10, s[8:11], s55 offen lds
    s_waitcnt lgkmcnt(6)
    v_mfma_f32_32x32x16_bf16 v[64:79], v[40:43], v[44:47], v[64:79]
    s_add_u32 m0, s54, 81920
    s_add_u32 s55, s60, 114688
    buffer_load_dwordx4 v11, s[12:15], s55 offen lds
    s_waitcnt lgkmcnt(3)
    v_mfma_f32_32x32x16_bf16 v[64:79], v[48:51], v[52:55], v[64:79]
    s_add_u32 m0, s54, 90112
    s_add_u32 s55, s60, 122880
    buffer_load_dwordx4 v11, s[12:15], s55 offen lds
    s_waitcnt lgkmcnt(0)
    v_mfma_f32_32x32x16_bf16 v[64:79], v[56:59], v[60:63], v[64:79]
    s_waitcnt vmcnt(12)
    s_barrier
    ds_read_b64_tr_b16 v[32:33], v30 offset:0
    ds_read_b64_tr_b16 v[34:35], v30 offset:512
    ds_read_b128 v[36:39], v20 offset:0
    ds_read_b64_tr_b16 v[40:41], v30 offset:2048
    ds_read_b64_tr_b16 v[42:43], v30 offset:2560
    ds_read_b128 v[44:47], v21 offset:0
    ds_read_b64_tr_b16 v[48:49], v30 offset:4096
    ds_read_b64_tr_b16 v[50:51], v30 offset:4608
    ds_read_b128 v[52:55], v22 offset:0
    ds_read_b64_tr_b16 v[56:57], v30 offset:6144
    ds_read_b64_tr_b16 v[58:59], v30 offset:6656
    ds_read_b128 v[60:63], v23 offset:0
    s_add_u32 m0, s54, 98304
    s_add_u32 s55, s52, 131072
    buffer_load_dwordx4 v10, s[8:11], s55 offen lds
    s_waitcnt lgkmcnt(9)
    v_mfma_f32_32x32x16_bf16 v[64:79], v[32:35], v[36:39], v[64:79]
    s_add_u32 m0, s54, 106496
    s_add_u32 s55, s52, 139264
    buffer_load_dwordx4 v10, s[8:11], s55 offen lds
    s_waitcnt lgkmcnt(6)
    v_mfma_f32_32x32x16_bf16 v[64:79], v[40:43], v[44:47], v[64:79]
    s_add_u32 m0, s54, 114688
    s_add_u32 s55, s60, 131072
    buffer_load_dwordx4 v11, s[12:15], s55 offen lds
    s_waitcnt lgkmcnt(3)
    v_mfma_f32_32x32x16_bf16 v[64:79], v[48:51], v[52:55], v[64:79]
    s_add_u32 m0, s54, 122880
    s_add_u32 s55, s60, 139264
    buffer_load_dwordx4 v11, s[12:15], s55 offen lds
    s_waitcnt lgkmcnt(0)
    v_mfma_f32_32x32x16_bf16 v[64:79], v[56:59], v[60:63], v[64:79]
    s_waitcnt vmcnt(12)
    s_barrier
    ds_read_b64_tr_b16 v[32:33], v28 offset:0
    ds_read_b64_tr_b16 v[34:35], v28 offset:512
    ds_read_b128 v[36:39], v12 offset:0
    ds_read_b64_tr_b16 v[40:41], v28 offset:2048
    ds_read_b64_tr_b16 v[42:43], v28 offset:2560
    ds_read_b128 v[44:47], v13 offset:0
    ds_read_b64_tr_b16 v[48:49], v28 offset:4096
    ds_read_b64_tr_b16 v[50:51], v28 offset:4608
    ds_read_b128 v[52:55], v14 offset:0
    ds_read_b64_tr_b16 v[56:57], v28 offset:6144
    ds_read_b64_tr_b16 v[58:59], v28 offset:6656
    ds_read_b128 v[60:63], v15 offset:0
    s_add_u32 m0, s54, 131072
    s_add_u32 s55, s52, 147456
    buffer_load_dwordx4 v10, s[8:11], s55 offen lds
    s_waitcnt lgkmcnt(9)
    v_mfma_f32_32x32x16_bf16 v[64:79], v[32:35], v[36:39], v[64:79]
    s_add_u32 m0, s54, 139264
    s_add_u32 s55, s52, 155648
    buffer_load_dwordx4 v10, s[8:11], s55 offen lds
    s_waitcnt lgkmcnt(6)
    v_mfma_f32_32x32x16_bf16 v[64:79], v[40:43], v[44:47], v[64:79]
    s_add_u32 m0, s54, 147456
    s_add_u32 s55, s60, 147456
    buffer_load_dwordx4 v11, s[12:15], s55 offen lds
    s_waitcnt lgkmcnt(3)
    v_mfma_f32_32x32x16_bf16 v[64:79], v[48:51], v[52:55], v[64:79]
    s_add_u32 m0, s54, 155648
    s_add_u32 s55, s60, 155648
    buffer_load_dwordx4 v11, s[12:15], s55 offen lds
    s_waitcnt lgkmcnt(0)
    v_mfma_f32_32x32x16_bf16 v[64:79], v[56:59], v[60:63], v[64:79]
    s_waitcnt vmcnt(12)
    s_barrier
    ds_read_b64_tr_b16 v[32:33], v28 offset:32768
    ds_read_b64_tr_b16 v[34:35], v28 offset:33280
    ds_read_b128 v[36:39], v12 offset:32768
    ds_read_b64_tr_b16 v[40:41], v28 offset:34816
    ds_read_b64_tr_b16 v[42:43], v28 offset:35328
    ds_read_b128 v[44:47], v13 offset:32768
    ds_read_b64_tr_b16 v[48:49], v28 offset:36864
    ds_read_b64_tr_b16 v[50:51], v28 offset:37376
    ds_read_b128 v[52:55], v14 offset:32768
    ds_read_b64_tr_b16 v[56:57], v28 offset:38912
    ds_read_b64_tr_b16 v[58:59], v28 offset:39424
    ds_read_b128 v[60:63], v15 offset:32768
    s_add_u32 m0, s54, 0
    s_add_u32 s55, s52, 163840
    buffer_load_dwordx4 v10, s[8:11], s55 offen lds
    s_waitcnt lgkmcnt(9)
    v_mfma_f32_32x32x16_bf16 v[64:79], v[32:35], v[36:39], v[64:79]
    s_add_u32 m0, s54, 8192
    s_add_u32 s55, s52, 172032
    buffer_load_dwordx4 v10, s[8:11], s55 offen lds
    s_waitcnt lgkmcnt(6)
    v_mfma_f32_32x32x16_bf16 v[64:79], v[40:43], v[44:47], v[64:79]
    s_add_u32 m0, s54, 16384
    s_add_u32 s55, s60, 163840
    buffer_load_dwordx4 v11, s[12:15], s55 offen lds
    s_waitcnt lgkmcnt(3)
    v_mfma_f32_32x32x16_bf16 v[64:79], v[48:51], v[52:55], v[64:79]
    s_add_u32 m0, s54, 24576
    s_add_u32 s55, s60, 172032
    buffer_load_dwordx4 v11, s[12:15], s55 offen lds
    s_waitcnt lgkmcnt(0)
    v_mfma_f32_32x32x16_bf16 v[64:79], v[56:59], v[60:63], v[64:79]
    s_waitcnt vmcnt(12)
    s_barrier
    ds_read_b64_tr_b16 v[32:33], v29 offset:0
    ds_read_b64_tr_b16 v[34:35], v29 offset:512
    ds_read_b128 v[36:39], v16 offset:0
    ds_read_b64_tr_b16 v[40:41], v29 offset:2048
    ds_read_b64_tr_b16 v[42:43], v29 offset:2560
    ds_read_b128 v[44:47], v17 offset:0
    ds_read_b64_tr_b16 v[48:49], v29 offset:4096
    ds_read_b64_tr_b16 v[50:51], v29 offset:4608
    ds_read_b128 v[52:55], v18 offset:0
    ds_read_b64_tr_b16 v[56:57], v29 offset:6144
    ds_read_b64_tr_b16 v[58:59], v29 offset:6656
    ds_read_b128 v[60:63], v19 offset:0
    s_add_u32 m0, s54, 32768
    s_add_u32 s55, s52, 180224
    buffer_load_dwordx4 v10, s[8:11], s55 offen lds
    s_waitcnt lgkmcnt(9)
    v_mfma_f32_32x32x16_bf16 v[64:79], v[32:35], v[36:39], v[64:79]
    s_add_u32 m0, s54, 40960
    s_add_u32 s55, s52, 188416
    buffer_load_dwordx4 v10, s[8:11], s55 offen lds
    s_waitcnt lgkmcnt(6)
    v_mfma_f32_32x32x16_bf16 v[64:79], v[40:43], v[44:47], v[64:79]
    s_add_u32 m0, s54, 49152
    s_add_u32 s55, s60, 180224
    buffer_load_dwordx4 v11, s[12:15], s55 offen lds
    s_waitcnt lgkmcnt(3)
    v_mfma_f32_32x32x16_bf16 v[64:79], v[48:51], v[52:55], v[64:79]
    s_add_u32 m0, s54, 57344
    s_add_u32 s55, s60, 188416
    buffer_load_dwordx4 v11, s[12:15], s55 offen lds
    s_waitcnt lgkmcnt(0)
    v_mfma_f32_32x32x16_bf16 v[64:79], v[56:59], v[60:63], v[64:79]
    s_waitcnt vmcnt(12)
    s_barrier
    ds_read_b64_tr_b16 v[32:33], v29 offset:32768
    ds_read_b64_tr_b16 v[34:35], v29 offset:33280
    ds_read_b128 v[36:39], v16 offset:32768
    ds_read_b64_tr_b16 v[40:41], v29 offset:34816
    ds_read_b64_tr_b16 v[42:43], v29 offset:35328
    ds_read_b128 v[44:47], v17 offset:32768
    ds_read_b64_tr_b16 v[48:49], v29 offset:36864
    ds_read_b64_tr_b16 v[50:51], v29 offset:37376
    ds_read_b128 v[52:55], v18 offset:32768
    ds_read_b64_tr_b16 v[56:57], v29 offset:38912
    ds_read_b64_tr_b16 v[58:59], v29 offset:39424
    ds_read_b128 v[60:63], v19 offset:32768
    s_add_u32 m0, s54, 65536
    s_add_u32 s55, s52, 196608
    buffer_load_dwordx4 v10, s[8:11], s55 offen lds
    s_waitcnt lgkmcnt(9)
    v_mfma_f32_32x32x16_bf16 v[64:79], v[32:35], v[36:39], v[64:79]
    s_add_u32 m0, s54, 73728
    s_add_u32 s55, s52, 204800
    buffer_load_dwordx4 v10, s[8:11], s55 offen lds
    s_waitcnt lgkmcnt(6)
    v_mfma_f32_32x32x16_bf16 v[64:79], v[40:43], v[44:47], v[64:79]
    s_add_u32 m0, s54, 81920
    s_add_u32 s55, s60, 196608
    buffer_load_dwordx4 v11, s[12:15], s55 offen lds
    s_waitcnt lgkmcnt(3)
    v_mfma_f32_32x32x16_bf16 v[64:79], v[48:51], v[52:55], v[64:79]
    s_add_u32 m0, s54, 90112
    s_add_u32 s55, s60, 204800
    buffer_load_dwordx4 v11, s[12:15], s55 offen lds
    s_waitcnt lgkmcnt(0)
    v_mfma_f32_32x32x16_bf16 v[64:79], v[56:59], v[60:63], v[64:79]
    s_waitcnt vmcnt(12)
    s_barrier
    ds_read_b64_tr_b16 v[32:33], v30 offset:0
    ds_read_b64_tr_b16 v[34:35], v30 offset:512
    ds_read_b128 v[36:39], v20 offset:0
    ds_read_b64_tr_b16 v[40:41], v30 offset:2048
    ds_read_b64_tr_b16 v[42:43], v30 offset:2560
    ds_read_b128 v[44:47], v21 offset:0
    ds_read_b64_tr_b16 v[48:49], v30 offset:4096
    ds_read_b64_tr_b16 v[50:51], v30 offset:4608
    ds_read_b128 v[52:55], v22 offset:0
    ds_read_b64_tr_b16 v[56:57], v30 offset:6144
    ds_read_b64_tr_b16 v[58:59], v30 offset:6656
    ds_read_b128 v[60:63], v23 offset:0
    s_add_u32 m0, s54, 98304
    s_add_u32 s55, s52, 212992
    buffer_load_dwordx4 v10, s[8:11], s55 offen lds
    s_waitcnt lgkmcnt(9)
    v_mfma_f32_32x32x16_bf16 v[64:79], v[32:35], v[36:39], v[64:79]
    s_add_u32 m0, s54, 106496
    s_add_u32 s55, s52, 221184
    buffer_load_dwordx4 v10, s[8:11], s55 offen lds
    s_waitcnt lgkmcnt(6)
    v_mfma_f32_32x32x16_bf16 v[64:79], v[40:43], v[44:47], v[64:79]
    s_add_u32 m0, s54, 114688
    s_add_u32 s55, s60, 212992
    buffer_load_dwordx4 v11, s[12:15], s55 offen lds
    s_waitcnt lgkmcnt(3)
    v_mfma_f32_32x32x16_bf16 v[64:79], v[48:51], v[52:55], v[64:79]
    s_add_u32 m0, s54, 122880
    s_add_u32 s55, s60, 221184
    buffer_load_dwordx4 v11, s[12:15], s55 offen lds
    s_waitcnt lgkmcnt(0)
    v_mfma_f32_32x32x16_bf16 v[64:79], v[56:59], v[60:63], v[64:79]
    s_waitcnt vmcnt(12)
    s_barrier
    ds_read_b64_tr_b16 v[32:33], v28 offset:0
    ds_read_b64_tr_b16 v[34:35], v28 offset:512
    ds_read_b128 v[36:39], v12 offset:0
    ds_read_b64_tr_b16 v[40:41], v28 offset:2048
    ds_read_b64_tr_b16 v[42:43], v28 offset:2560
    ds_read_b128 v[44:47], v13 offset:0
    ds_read_b64_tr_b16 v[48:49], v28 offset:4096
    ds_read_b64_tr_b16 v[50:51], v28 offset:4608
    ds_read_b128 v[52:55], v14 offset:0
    ds_read_b64_tr_b16 v[56:57], v28 offset:6144
    ds_read_b64_tr_b16 v[58:59], v28 offset:6656
    ds_read_b128 v[60:63], v15 offset:0
    s_waitcnt lgkmcnt(9)
    v_mfma_f32_32x32x16_bf16 v[64:79], v[32:35], v[36:39], v[64:79]
    s_waitcnt lgkmcnt(6)
    v_mfma_f32_32x32x16_bf16 v[64:79], v[40:43], v[44:47], v[64:79]
    s_waitcnt lgkmcnt(3)
    v_mfma_f32_32x32x16_bf16 v[64:79], v[48:51], v[52:55], v[64:79]
    s_waitcnt lgkmcnt(0)
    v_mfma_f32_32x32x16_bf16 v[64:79], v[56:59], v[60:63], v[64:79]
    s_waitcnt vmcnt(8)
    s_barrier
    buffer_load_dwordx4 v[24:27], v80, s[16:19], s53 offen
    ds_read_b64_tr_b16 v[32:33], v28 offset:32768
    ds_read_b64_tr_b16 v[34:35], v28 offset:33280
    ds_read_b128 v[36:39], v12 offset:32768
    ds_read_b64_tr_b16 v[40:41], v28 offset:34816
    ds_read_b64_tr_b16 v[42:43], v28 offset:35328
    ds_read_b128 v[44:47], v13 offset:32768
    ds_read_b64_tr_b16 v[48:49], v28 offset:36864
    ds_read_b64_tr_b16 v[50:51], v28 offset:37376
    ds_read_b128 v[52:55], v14 offset:32768
    ds_read_b64_tr_b16 v[56:57], v28 offset:38912
    ds_read_b64_tr_b16 v[58:59], v28 offset:39424
    ds_read_b128 v[60:63], v15 offset:32768
    s_waitcnt lgkmcnt(9)
    v_mfma_f32_32x32x16_bf16 v[64:79], v[32:35], v[36:39], v[64:79]
    s_waitcnt lgkmcnt(6)
    v_mfma_f32_32x32x16_bf16 v[64:79], v[40:43], v[44:47], v[64:79]
    s_waitcnt lgkmcnt(3)
    v_mfma_f32_32x32x16_bf16 v[64:79], v[48:51], v[52:55], v[64:79]
    s_waitcnt lgkmcnt(0)
    v_mfma_f32_32x32x16_bf16 v[64:79], v[56:59], v[60:63], v[64:79]
    s_waitcnt vmcnt(5)
    s_barrier
    ds_read_b64_tr_b16 v[32:33], v29 offset:0
    ds_read_b64_tr_b16 v[34:35], v29 offset:512
    ds_read_b128 v[36:39], v16 offset:0
    ds_read_b64_tr_b16 v[40:41], v29 offset:2048
    ds_read_b64_tr_b16 v[42:43], v29 offset:2560
    ds_read_b128 v[44:47], v17 offset:0
    ds_read_b64_tr_b16 v[48:49], v29 offset:4096
    ds_read_b64_tr_b16 v[50:51], v29 offset:4608
    ds_read_b128 v[52:55], v18 offset:0
    ds_read_b64_tr_b16 v[56:57], v29 offset:6144
    ds_read_b64_tr_b16 v[58:59], v29 offset:6656
    ds_read_b128 v[60:63], v19 offset:0
    s_waitcnt lgkmcnt(9)
    v_mfma_f32_32x32x16_bf16 v[64:79], v[32:35], v[36:39], v[64:79]
    s_waitcnt lgkmcnt(6)
    v_mfma_f32_32x32x16_bf16 v[64:79], v[40:43], v[44:47], v[64:79]
    s_waitcnt lgkmcnt(3)
    v_mfma_f32_32x32x16_bf16 v[64:79], v[48:51], v[52:55], v[64:79]
    s_waitcnt lgkmcnt(0)
    v_mfma_f32_32x32x16_bf16 v[64:79], v[56:59], v[60:63], v[64:79]
    s_waitcnt vmcnt(0)
    s_barrier
    ds_read_b64_tr_b16 v[32:33], v29 offset:32768
    ds_read_b64_tr_b16 v[34:35], v29 offset:33280
    ds_read_b128 v[36:39], v16 offset:32768
    ds_read_b64_tr_b16 v[40:41], v29 offset:34816
    ds_read_b64_tr_b16 v[42:43], v29 offset:35328
    ds_read_b128 v[44:47], v17 offset:32768
    ds_read_b64_tr_b16 v[48:49], v29 offset:36864
    ds_read_b64_tr_b16 v[50:51], v29 offset:37376
    ds_read_b128 v[52:55], v18 offset:32768
    ds_read_b64_tr_b16 v[56:57], v29 offset:38912
    ds_read_b64_tr_b16 v[58:59], v29 offset:39424
    ds_read_b128 v[60:63], v19 offset:32768
    s_waitcnt lgkmcnt(9)
    v_mfma_f32_32x32x16_bf16 v[64:79], v[32:35], v[36:39], v[64:79]
    s_waitcnt lgkmcnt(6)
    v_mfma_f32_32x32x16_bf16 v[64:79], v[40:43], v[44:47], v[64:79]
    s_waitcnt lgkmcnt(3)
    v_mfma_f32_32x32x16_bf16 v[64:79], v[48:51], v[52:55], v[64:79]
    s_waitcnt lgkmcnt(0)
    v_mfma_f32_32x32x16_bf16 v[64:79], v[56:59], v[60:63], v[64:79]
    v_and_b32 v3, 31, v2
    s_lshl_b32 s51, s57, 5
    v_add_u32 v3, s51, v3
    v_mul_u32_u24 v3, 272, v3
    v_lshrrev_b32 v4, 5, v2
    v_lshl_add_u32 v3, v4, 4, v3
    s_mul_i32 s51, s58, 17408
    s_lshl_b32 s55, s56, 7
    s_add_u32 s51, s51, s55
    s_add_u32 s51, s51, 0
    v_add_u32 v3, s51, v3
    s_nop 7
    ds_write_b128 v3, v[64:67] offset:0
    ds_write_b128 v3, v[68:71] offset:32
    ds_write_b128 v3, v[72:75] offset:64
    ds_write_b128 v3, v[76:79] offset:96
    v_lshrrev_b32 v5, 3, v2
    s_lshl_b32 s51, s48, 3
    v_add_u32 v5, s51, v5
    v_mul_u32_u24 v5, 272, v5
    v_and_b32 v6, 7, v2
    v_lshl_add_u32 v5, v6, 5, v5
    v_add_u32 v5, 0, v5
    s_waitcnt lgkmcnt(0)
    s_barrier
    ds_read_b128 v[40:43], v5
    ds_read_b128 v[44:47], v5 offset:16
    ds_read_b128 v[48:51], v5 offset:17408
    ds_read_b128 v[52:55], v5 offset:17424
    s_waitcnt vmcnt(0)
    v_lshlrev_b32 v56, 16, v24
    v_and_b32 v57, 0xffff0000, v24
    v_lshlrev_b32 v58, 16, v25
    v_and_b32 v59, 0xffff0000, v25
    v_lshlrev_b32 v60, 16, v26
    v_and_b32 v61, 0xffff0000, v26
    v_lshlrev_b32 v62, 16, v27
    v_and_b32 v63, 0xffff0000, v27
    s_waitcnt lgkmcnt(0)
    v_add_f32 v40, v40, v48
    v_add_f32 v41, v41, v49
    v_add_f32 v42, v42, v50
    v_add_f32 v43, v43, v51
    v_add_f32 v44, v44, v52
    v_add_f32 v45, v45, v53
    v_add_f32 v46, v46, v54
    v_add_f32 v47, v47, v55
    v_add_f32 v40, v40, v56
    v_add_f32 v41, v41, v57
    v_add_f32 v42, v42, v58
    v_add_f32 v43, v43, v59
    v_add_f32 v44, v44, v60
    v_add_f32 v45, v45, v61
    v_add_f32 v46, v46, v62
    v_add_f32 v47, v47, v63
    v_cvt_pk_bf16_f32 v32, v40, v41
    v_cvt_pk_bf16_f32 v33, v42, v43
    v_cvt_pk_bf16_f32 v34, v44, v45
    v_cvt_pk_bf16_f32 v35, v46, v47
    buffer_store_dwordx4 v[32:35], v81, s[20:23], s59 offen sc1
L_g2_done_301:
    s_endpgm
.globl r1_kernel
.p2align 8
.type r1_kernel,@function
r1_kernel:
    s_load_dwordx2 s[4:5], s[0:1], 88
    s_load_dwordx2 s[40:41], s[0:1], 24
    s_load_dwordx2 s[42:43], s[0:1], 32
    s_load_dwordx2 s[44:45], s[0:1], 88
    s_cmp_ge_u32 s2, 256
    s_cbranch_scc1 L_r_done_401
    s_and_b32 s46, s2, 7
    s_lshl_b32 s46, s46, 1
    s_bfe_u32 s47, s2, 0x10003
    s_add_u32 s46, s46, s47
    s_lshr_b32 s47, s2, 4
    v_lshrrev_b32 v1, 6, v0
    v_and_b32 v2, 63, v0
    v_readfirstlane_b32 s48, v1
    v_and_b32 v3, 15, v2
    v_lshrrev_b32 v4, 4, v2
    s_lshl_b32 s49, s48, 4
    v_add_u32 v5, 0, v4
    v_xor_b32 v6, v5, v3
    v_add_u32 v5, s49, v5
    v_lshlrev_b32 v5, 10, v5
    v_lshl_add_u32 v8, v6, 4, v5
    v_add_u32 v5, 4, v4
    v_xor_b32 v6, v5, v3
    v_add_u32 v5, s49, v5
    v_lshlrev_b32 v5, 10, v5
    v_lshl_add_u32 v9, v6, 4, v5
    v_add_u32 v5, 8, v4
    v_xor_b32 v6, v5, v3
    v_add_u32 v5, s49, v5
    v_lshlrev_b32 v5, 10, v5
    v_lshl_add_u32 v10, v6, 4, v5
    v_add_u32 v5, 12, v4
    v_xor_b32 v6, v5, v3
    v_add_u32 v5, s49, v5
    v_lshlrev_b32 v5, 10, v5
    v_lshl_add_u32 v11, v6, 4, v5
    s_lshl_b32 s50, s46, 17
    s_and_b32 s51, s48, 3
    s_lshl_b32 s51, s51, 2
    s_lshl_b32 s52, s47, 4
    s_add_u32 s52, s52, s51
    s_lshl_b32 s53, s48, 12
    s_add_u32 s53, s53, 131072
    s_lshl_b32 s54, s48, 14
    s_add_u32 s55, s51, 0
    v_xor_b32 v5, s55, v2
    v_lshlrev_b32 v12, 4, v5
    s_add_u32 s55, s51, 1
    v_xor_b32 v5, s55, v2
    v_lshlrev_b32 v13, 4, v5
    s_add_u32 s55, s51, 2
    v_xor_b32 v5, s55, v2
    v_lshlrev_b32 v14, 4, v5
    s_add_u32 s55, s51, 3
    v_xor_b32 v5, s55, v2
    v_lshlrev_b32 v15, 4, v5
    s_waitcnt lgkmcnt(0)
    s_add_u32 s8, s4, 14680064
    s_addc_u32 s9, s5, 0
    s_mov_b32 s10, 2097152
    s_mov_b32 s11, 0x00020000
    s_cmp_ge_u32 s48, 4
    s_cselect_b32 s12, s42, s40
    s_cselect_b32 s13, s43, s41
    s_mov_b32 s14, 0x80000
    s_mov_b32 s15, 0x00020000
    s_add_u32 s55, s52, 0
    s_cmp_eq_u32 s55, 0
    s_cselect_b32 s55, 256, s55
    s_lshl_b32 s55, s55, 10
    s_add_u32 m0, s53, 0
    s_nop 0
    buffer_load_dwordx4 v12, s[12:15], s55 offen lds
    s_add_u32 s55, s52, 1
    s_lshl_b32 s55, s55, 10
    s_add_u32 m0, s53, 1024
    s_nop 0
    buffer_load_dwordx4 v13, s[12:15], s55 offen lds
    s_add_u32 s55, s52, 2
    s_lshl_b32 s55, s55, 10
    s_add_u32 m0, s53, 2048
    s_nop 0
    buffer_load_dwordx4 v14, s[12:15], s55 offen lds
    s_add_u32 s55, s52, 3
    s_lshl_b32 s55, s55, 10
    s_add_u32 m0, s53, 3072
    s_nop 0
    buffer_load_dwordx4 v15, s[12:15], s55 offen lds
    s_add_u32 s60, s48, s47
    s_and_b32 s59, s60, 3
    s_add_u32 s60, s59, 0
    s_and_b32 s60, s60, 3
    s_lshl_b32 s60, s60, 8
    s_add_u32 s61, s59, 1
    s_and_b32 s61, s61, 3
    s_lshl_b32 s61, s61, 8
    s_add_u32 s62, s59, 2
    s_and_b32 s62, s62, 3
    s_lshl_b32 s62, s62, 8
    s_add_u32 s63, s59, 3
    s_and_b32 s63, s63, 3
    s_lshl_b32 s63, s63, 8
    s_sub_u32 s33, s61, s60
    s_sub_u32 s34, s62, s61
    s_sub_u32 s35, s63, s62
    s_mov_b32 s36, s60
    s_add_u32 s60, s60, s50
    s_add_u32 s61, s61, s50
    s_add_u32 s62, s62, s50
    s_add_u32 s63, s63, s50
    s_add_u32 m0, s54, 0
    s_nop 0
    buffer_load_dwordx4 v8, s[8:11], s60 offen lds
    s_add_u32 m0, s54, 1024
    s_nop 0
    buffer_load_dwordx4 v9, s[8:11], s60 offen lds
    s_add_u32 m0, s54, 2048
    s_nop 0
    buffer_load_dwordx4 v10, s[8:11], s60 offen lds
    s_add_u32 m0, s54, 3072
    s_nop 0
    buffer_load_dwordx4 v11, s[8:11], s60 offen lds
    s_add_u32 m0, s54, 4096
    s_nop 0
    buffer_load_dwordx4 v8, s[8:11], s61 offen lds
    s_mov_b32 s28, s44
    s_mov_b32 s29, s45
    s_mov_b32 s30, 2097152
    s_mov_b32 s31, 0x00020000
    v_add_u32 v6, s49, v3
    v_cvt_f32_u32 v5, v6
    v_mul_f32 v5, 0x3c000000, v5
    s_add_u32 m0, s54, 5120
    s_nop 0
    buffer_load_dwordx4 v9, s[8:11], s61 offen lds
    v_lshlrev_b32 v7, 3, v4
    v_cvt_f32_u32 v7, v7
    v_mul_f32 v48, v7, v5
    v_add_f32 v49, v48, v5
    v_add_f32 v50, v49, v5
    v_add_f32 v51, v50, v5
    v_add_f32 v52, v51, v5
    s_add_u32 m0, s54, 6144
    s_nop 0
    buffer_load_dwordx4 v10, s[8:11], s61 offen lds
    v_add_f32 v53, v52, v5
    v_add_f32 v54, v53, v5
    v_add_f32 v55, v54, v5
    v_cos_f32 v56, v48
    v_cos_f32 v57, v49
    v_cos_f32 v58, v50
    v_cos_f32 v59, v51
    s_add_u32 m0, s54, 7168
    s_nop 0
    buffer_load_dwordx4 v11, s[8:11], s61 offen lds
    v_cos_f32 v60, v52
    v_cos_f32 v61, v53
    v_cos_f32 v62, v54
    v_cos_f32 v63, v55
    v_sin_f32 v48, v48
    v_sin_f32 v49, v49
    v_sin_f32 v50, v50
    s_add_u32 m0, s54, 8192
    s_nop 0
    buffer_load_dwordx4 v8, s[8:11], s62 offen lds
    v_sin_f32 v51, v51
    v_sin_f32 v52, v52
    v_sin_f32 v53, v53
    v_sin_f32 v54, v54
    v_sin_f32 v55, v55
    v_mov_b32 v44, 0x80008000
    v_and_b32 v45, 2, v3
    s_add_u32 m0, s54, 9216
    s_nop 0
    buffer_load_dwordx4 v9, s[8:11], s62 offen lds
    v_cmp_ne_u32 vcc, 0, v45
    v_add_u32 v45, 1, v3
    v_cndmask_b32 v46, 0, v44, vcc
    v_and_b32 v45, 2, v45
    v_cmp_ne_u32 vcc, 0, v45
    v_and_b32 v45, 1, v3
    v_cndmask_b32 v47, 0, v44, vcc
    s_add_u32 m0, s54, 10240
    s_nop 0
    buffer_load_dwordx4 v10, s[8:11], s62 offen lds
    v_cmp_ne_u32 vcc, 0, v45
    s_nop 0
    v_cndmask_b32 v45, 0, v44, vcc
    v_cvt_pk_bf16_f32 v64, v56, v57
    v_cvt_pk_bf16_f32 v80, v48, v49
    v_cvt_pk_bf16_f32 v65, v58, v59
    v_cvt_pk_bf16_f32 v81, v50, v51
    s_add_u32 m0, s54, 11264
    s_nop 0
    buffer_load_dwordx4 v11, s[8:11], s62 offen lds
    v_cvt_pk_bf16_f32 v66, v60, v61
    v_cvt_pk_bf16_f32 v82, v52, v53
    v_cvt_pk_bf16_f32 v67, v62, v63
    v_cvt_pk_bf16_f32 v83, v54, v55
    v_cndmask_b32 v68, v64, v80, vcc
    v_cndmask_b32 v84, v80, v64, vcc
    v_cndmask_b32 v69, v65, v81, vcc
    v_cndmask_b32 v85, v81, v65, vcc
    v_cndmask_b32 v70, v66, v82, vcc
    v_cndmask_b32 v86, v82, v66, vcc
    v_cndmask_b32 v71, v67, v83, vcc
    v_cndmask_b32 v87, v83, v67, vcc
    s_add_u32 m0, s54, 12288
    s_nop 0
    buffer_load_dwordx4 v8, s[8:11], s63 offen lds
    v_xor_b32 v68, v68, v47
    v_xor_b32 v84, v84, v46
    s_add_u32 m0, s54, 13312
    s_nop 0
    buffer_load_dwordx4 v9, s[8:11], s63 offen lds
    v_xor_b32 v69, v69, v47
    v_xor_b32 v85, v85, v46
    v_xor_b32 v70, v70, v47
    v_xor_b32 v86, v86, v46
    v_xor_b32 v71, v71, v47
    v_xor_b32 v87, v87, v46
    v_xor_b32 v72, v64, v45
    s_add_u32 m0, s54, 14336
    s_nop 0
    buffer_load_dwordx4 v10, s[8:11], s63 offen lds
    v_xor_b32 v88, v80, v45
    v_xor_b32 v73, v65, v45
    v_xor_b32 v89, v81, v45
    v_xor_b32 v74, v66, v45
    v_xor_b32 v90, v82, v45
    v_xor_b32 v75, v67, v45
    v_xor_b32 v91, v83, v45
    s_add_u32 m0, s54, 15360
    s_nop 0
    buffer_load_dwordx4 v11, s[8:11], s63 offen lds
    v_xor_b32 v76, v68, v45
    v_xor_b32 v92, v84, v45
    v_xor_b32 v77, v69, v45
    v_xor_b32 v93, v85, v45
    v_xor_b32 v78, v70, v45
    v_xor_b32 v94, v86, v45
    v_xor_b32 v79, v71, v45
    v_xor_b32 v95, v87, v45
    v_lshlrev_b32 v5, 2, v4
    v_add_u32 v5, s49, v5
    v_add_u32 v7, 0, v5
    v_mul_u32_u24 v7, s46, v7
    v_cvt_f32_u32 v7, v7
    v_mul_f32 v7, 0xba000000, v7
    v_cos_f32 v96, v7
    v_sin_f32 v100, v7
    v_add_u32 v7, 1, v5
    v_mul_u32_u24 v7, s46, v7
    v_cvt_f32_u32 v7, v7
    v_mul_f32 v7, 0xba000000, v7
    v_cos_f32 v97, v7
    v_sin_f32 v101, v7
    v_add_u32 v7, 2, v5
    v_mul_u32_u24 v7, s46, v7
    v_cvt_f32_u32 v7, v7
    v_mul_f32 v7, 0xba000000, v7
    v_cos_f32 v98, v7
    v_sin_f32 v102, v7
    v_add_u32 v7, 3, v5
    v_mul_u32_u24 v7, s46, v7
    v_cvt_f32_u32 v7, v7
    v_mul_f32 v7, 0xba000000, v7
    v_cos_f32 v99, v7
    v_sin_f32 v103, v7
    v_lshlrev_b32 v7, 14, v5
    v_lshl_add_u32 v104, v3, 2, v7
    s_lshl_b32 s56, s46, 10
    s_lshl_b32 s57, s47, 6
    s_add_u32 s56, s56, s57
    v_lshrrev_b32 v5, 3, v3
    v_lshlrev_b32 v5, 7, v5
    v_lshl_add_u32 v5, v3, 5, v5
    v_lshl_add_u32 v5, v4, 3, v5
    v_add_u32 v105, s54, v5
    v_lshrrev_b32 v5, 1, v4
    v_lshlrev_b32 v5, 14, v5
    v_and_b32 v6, 1, v4
    v_mul_u32_u24 v6, 384, v6
    v_add_u32 v5, v5, v6
    v_lshrrev_b32 v6, 2, v3
    v_lshl_add_u32 v5, v6, 5, v5
    v_and_b32 v6, 3, v3
    v_lshl_add_u32 v106, v6, 3, v5
    v_add_u32 v107, 65536, v106
    v_add_u32 v5, 0, v4
    v_xor_b32 v5, v5, v3
    v_lshlrev_b32 v5, 4, v5
    v_lshl_add_u32 v16, v3, 8, v5
    v_add_u32 v16, s54, v16
    v_lshl_add_u32 v20, v3, 10, v5
    v_add_u32 v20, 131072, v20
    v_add_u32 v20, s36, v20
    v_add_u32 v5, 4, v4
    v_xor_b32 v5, v5, v3
    v_lshlrev_b32 v5, 4, v5
    v_lshl_add_u32 v17, v3, 8, v5
    v_add_u32 v17, s54, v17
    v_lshl_add_u32 v21, v3, 10, v5
    v_add_u32 v21, 131072, v21
    v_add_u32 v21, s36, v21
    v_add_u32 v5, 8, v4
    v_xor_b32 v5, v5, v3
    v_lshlrev_b32 v5, 4, v5
    v_lshl_add_u32 v18, v3, 8, v5
    v_add_u32 v18, s54, v18
    v_lshl_add_u32 v22, v3, 10, v5
    v_add_u32 v22, 131072, v22
    v_add_u32 v22, s36, v22
    v_add_u32 v5, 12, v4
    v_xor_b32 v5, v5, v3
    v_lshlrev_b32 v5, 4, v5
    v_lshl_add_u32 v19, v3, 8, v5
    v_add_u32 v19, s54, v19
    v_lshl_add_u32 v23, v3, 10, v5
    v_add_u32 v23, 131072, v23
    v_add_u32 v23, s36, v23
    v_mov_b32 v24, 0x3f803f80
    v_mov_b32 v25, 0x3f803f80
    v_mov_b32 v26, 0x3f803f80
    v_mov_b32 v27, 0x3f803f80
    v_mov_b32 v14, 0
    v_mov_b32 v15, 0
    s_waitcnt vmcnt(12)
    s_barrier
    ds_read_b128 v[116:119], v16 offset:0
    ds_read_b128 v[108:111], v20 offset:0
    ds_read_b128 v[112:115], v20 offset:16384
    ds_read_b128 v[128:131], v17 offset:0
    ds_read_b128 v[120:123], v21 offset:0
    ds_read_b128 v[124:127], v21 offset:16384
    ds_read_b128 v[140:143], v18 offset:0
    ds_read_b128 v[132:135], v22 offset:0
    ds_read_b128 v[136:139], v22 offset:16384
    ds_read_b128 v[152:155], v19 offset:0
    ds_read_b128 v[144:147], v23 offset:0
    ds_read_b128 v[148:151], v23 offset:16384
    v_add_u32 v20, s33, v20
    v_add_u32 v21, s33, v21
    v_add_u32 v22, s33, v22
    v_add_u32 v23, s33, v23
    s_waitcnt lgkmcnt(9)
    v_mfma_f32_16x16x32_bf16 v[28:31], v[108:111], v[116:119], 0
    v_dot2_f32_bf16 v14, v116, v116, v14
    v_dot2_f32_bf16 v15, v117, v117, v15
    v_mfma_f32_16x16x32_bf16 v[32:35], v[112:115], v[116:119], 0
    v_dot2_f32_bf16 v14, v118, v118, v14
    v_dot2_f32_bf16 v15, v119, v119, v15
    v_mfma_f32_16x16x32_bf16 v[36:39], v[24:27], v[116:119], 0
    s_waitcnt lgkmcnt(6)
    v_mfma_f32_16x16x32_bf16 v[28:31], v[120:123], v[128:131], v[28:31]
    v_dot2_f32_bf16 v14, v128, v128, v14
    v_dot2_f32_bf16 v15, v129, v129, v15
    v_mfma_f32_16x16x32_bf16 v[32:35], v[124:127], v[128:131], v[32:35]
    v_dot2_f32_bf16 v14, v130, v130, v14
    v_dot2_f32_bf16 v15, v131, v131, v15
    v_mfma_f32_16x16x32_bf16 v[36:39], v[24:27], v[128:131], v[36:39]
    s_waitcnt lgkmcnt(3)
    v_mfma_f32_16x16x32_bf16 v[28:31], v[132:135], v[140:143], v[28:31]
    v_dot2_f32_bf16 v14, v140, v140, v14
    v_dot2_f32_bf16 v15, v141, v141, v15
    v_mfma_f32_16x16x32_bf16 v[32:35], v[136:139], v[140:143], v[32:35]
    v_dot2_f32_bf16 v14, v142, v142, v14
    v_dot2_f32_bf16 v15, v143, v143, v15
    v_mfma_f32_16x16x32_bf16 v[36:39], v[24:27], v[140:143], v[36:39]
    s_waitcnt lgkmcnt(0)
    v_mfma_f32_16x16x32_bf16 v[28:31], v[144:147], v[152:155], v[28:31]
    v_dot2_f32_bf16 v14, v152, v152, v14
    v_dot2_f32_bf16 v15, v153, v153, v15
    v_mfma_f32_16x16x32_bf16 v[32:35], v[148:151], v[152:155], v[32:35]
    v_dot2_f32_bf16 v14, v154, v154, v14
    v_dot2_f32_bf16 v15, v155, v155, v15
    v_mfma_f32_16x16x32_bf16 v[36:39], v[24:27], v[152:155], v[36:39]
    s_waitcnt vmcnt(8)
    ds_read_b128 v[116:119], v16 offset:4096
    ds_read_b128 v[108:111], v20 offset:0
    ds_read_b128 v[112:115], v20 offset:16384
    ds_read_b128 v[128:131], v17 offset:4096
    ds_read_b128 v[120:123], v21 offset:0
    ds_read_b128 v[124:127], v21 offset:16384
    ds_read_b128 v[140:143], v18 offset:4096
    ds_read_b128 v[132:135], v22 offset:0
    ds_read_b128 v[136:139], v22 offset:16384
    ds_read_b128 v[152:155], v19 offset:4096
    ds_read_b128 v[144:147], v23 offset:0
    ds_read_b128 v[148:151], v23 offset:16384
    v_add_u32 v20, s34, v20
    v_add_u32 v21, s34, v21
    v_add_u32 v22, s34, v22
    v_add_u32 v23, s34, v23
    s_waitcnt lgkmcnt(9)
    v_mfma_f32_16x16x32_bf16 v[28:31], v[108:111], v[116:119], v[28:31]
    v_dot2_f32_bf16 v14, v116, v116, v14
    v_dot2_f32_bf16 v15, v117, v117, v15
    v_mfma_f32_16x16x32_bf16 v[32:35], v[112:115], v[116:119], v[32:35]
    v_dot2_f32_bf16 v14, v118, v118, v14
    v_dot2_f32_bf16 v15, v119, v119, v15
    v_mfma_f32_16x16x32_bf16 v[36:39], v[24:27], v[116:119], v[36:39]
    s_waitcnt lgkmcnt(6)
    v_mfma_f32_16x16x32_bf16 v[28:31], v[120:123], v[128:131], v[28:31]
    v_dot2_f32_bf16 v14, v128, v128, v14
    v_dot2_f32_bf16 v15, v129, v129, v15
    v_mfma_f32_16x16x32_bf16 v[32:35], v[124:127], v[128:131], v[32:35]
    v_dot2_f32_bf16 v14, v130, v130, v14
    v_dot2_f32_bf16 v15, v131, v131, v15
    v_mfma_f32_16x16x32_bf16 v[36:39], v[24:27], v[128:131], v[36:39]
    s_waitcnt lgkmcnt(3)
    v_mfma_f32_16x16x32_bf16 v[28:31], v[132:135], v[140:143], v[28:31]
    v_dot2_f32_bf16 v14, v140, v140, v14
    v_dot2_f32_bf16 v15, v141, v141, v15
    v_mfma_f32_16x16x32_bf16 v[32:35], v[136:139], v[140:143], v[32:35]
    v_dot2_f32_bf16 v14, v142, v142, v14
    v_dot2_f32_bf16 v15, v143, v143, v15
    v_mfma_f32_16x16x32_bf16 v[36:39], v[24:27], v[140:143], v[36:39]
    s_waitcnt lgkmcnt(0)
    v_mfma_f32_16x16x32_bf16 v[28:31], v[144:147], v[152:155], v[28:31]
    v_dot2_f32_bf16 v14, v152, v152, v14
    v_dot2_f32_bf16 v15, v153, v153, v15
    v_mfma_f32_16x16x32_bf16 v[32:35], v[148:151], v[152:155], v[32:35]
    v_dot2_f32_bf16 v14, v154, v154, v14
    v_dot2_f32_bf16 v15, v155, v155, v15
    v_mfma_f32_16x16x32_bf16 v[36:39], v[24:27], v[152:155], v[36:39]
    s_waitcnt vmcnt(4)
    ds_read_b128 v[116:119], v16 offset:8192
    ds_read_b128 v[108:111], v20 offset:0
    ds_read_b128 v[112:115], v20 offset:16384
    ds_read_b128 v[128:131], v17 offset:8192
    ds_read_b128 v[120:123], v21 offset:0
    ds_read_b128 v[124:127], v21 offset:16384
    ds_read_b128 v[140:143], v18 offset:8192
    ds_read_b128 v[132:135], v22 offset:0
    ds_read_b128 v[136:139], v22 offset:16384
    ds_read_b128 v[152:155], v19 offset:8192
    ds_read_b128 v[144:147], v23 offset:0
    ds_read_b128 v[148:151], v23 offset:16384
    v_add_u32 v20, s35, v20
    v_add_u32 v21, s35, v21
    v_add_u32 v22, s35, v22
    v_add_u32 v23, s35, v23
    s_waitcnt lgkmcnt(9)
    v_mfma_f32_16x16x32_bf16 v[28:31], v[108:111], v[116:119], v[28:31]
    v_dot2_f32_bf16 v14, v116, v116, v14
    v_dot2_f32_bf16 v15, v117, v117, v15
    v_mfma_f32_16x16x32_bf16 v[32:35], v[112:115], v[116:119], v[32:35]
    v_dot2_f32_bf16 v14, v118, v118, v14
    v_dot2_f32_bf16 v15, v119, v119, v15
    v_mfma_f32_16x16x32_bf16 v[36:39], v[24:27], v[116:119], v[36:39]
    s_waitcnt lgkmcnt(6)
    v_mfma_f32_16x16x32_bf16 v[28:31], v[120:123], v[128:131], v[28:31]
    v_dot2_f32_bf16 v14, v128, v128, v14
    v_dot2_f32_bf16 v15, v129, v129, v15
    v_mfma_f32_16x16x32_bf16 v[32:35], v[124:127], v[128:131], v[32:35]
    v_dot2_f32_bf16 v14, v130, v130, v14
    v_dot2_f32_bf16 v15, v131, v131, v15
    v_mfma_f32_16x16x32_bf16 v[36:39], v[24:27], v[128:131], v[36:39]
    s_waitcnt lgkmcnt(3)
    v_mfma_f32_16x16x32_bf16 v[28:31], v[132:135], v[140:143], v[28:31]
    v_dot2_f32_bf16 v14, v140, v140, v14
    v_dot2_f32_bf16 v15, v141, v141, v15
    v_mfma_f32_16x16x32_bf16 v[32:35], v[136:139], v[140:143], v[32:35]
    v_dot2_f32_bf16 v14, v142, v142, v14
    v_dot2_f32_bf16 v15, v143, v143, v15
    v_mfma_f32_16x16x32_bf16 v[36:39], v[24:27], v[140:143], v[36:39]
    s_waitcnt lgkmcnt(0)
    v_mfma_f32_16x16x32_bf16 v[28:31], v[144:147], v[152:155], v[28:31]
    v_dot2_f32_bf16 v14, v152, v152, v14
    v_dot2_f32_bf16 v15, v153, v153, v15
    v_mfma_f32_16x16x32_bf16 v[32:35], v[148:151], v[152:155], v[32:35]
    v_dot2_f32_bf16 v14, v154, v154, v14
    v_dot2_f32_bf16 v15, v155, v155, v15
    v_mfma_f32_16x16x32_bf16 v[36:39], v[24:27], v[152:155], v[36:39]
    s_waitcnt vmcnt(0)
    ds_read_b128 v[116:119], v16 offset:12288
    ds_read_b128 v[108:111], v20 offset:0
    ds_read_b128 v[112:115], v20 offset:16384
    ds_read_b128 v[128:131], v17 offset:12288
    ds_read_b128 v[120:123], v21 offset:0
    ds_read_b128 v[124:127], v21 offset:16384
    ds_read_b128 v[140:143], v18 offset:12288
    ds_read_b128 v[132:135], v22 offset:0
    ds_read_b128 v[136:139], v22 offset:16384
    ds_read_b128 v[152:155], v19 offset:12288
    ds_read_b128 v[144:147], v23 offset:0
    ds_read_b128 v[148:151], v23 offset:16384
    s_waitcnt lgkmcnt(9)
    v_mfma_f32_16x16x32_bf16 v[28:31], v[108:111], v[116:119], v[28:31]
    v_dot2_f32_bf16 v14, v116, v116, v14
    v_dot2_f32_bf16 v15, v117, v117, v15
    v_mfma_f32_16x16x32_bf16 v[32:35], v[112:115], v[116:119], v[32:35]
    v_dot2_f32_bf16 v14, v118, v118, v14
    v_dot2_f32_bf16 v15, v119, v119, v15
    v_mfma_f32_16x16x32_bf16 v[36:39], v[24:27], v[116:119], v[36:39]
    s_waitcnt lgkmcnt(6)
    v_mfma_f32_16x16x32_bf16 v[28:31], v[120:123], v[128:131], v[28:31]
    v_dot2_f32_bf16 v14, v128, v128, v14
    v_dot2_f32_bf16 v15, v129, v129, v15
    v_mfma_f32_16x16x32_bf16 v[32:35], v[124:127], v[128:131], v[32:35]
    v_dot2_f32_bf16 v14, v130, v130, v14
    v_dot2_f32_bf16 v15, v131, v131, v15
    v_mfma_f32_16x16x32_bf16 v[36:39], v[24:27], v[128:131], v[36:39]
    s_waitcnt lgkmcnt(3)
    v_mfma_f32_16x16x32_bf16 v[28:31], v[132:135], v[140:143], v[28:31]
    v_dot2_f32_bf16 v14, v140, v140, v14
    v_dot2_f32_bf16 v15, v141, v141, v15
    v_mfma_f32_16x16x32_bf16 v[32:35], v[136:139], v[140:143], v[32:35]
    v_dot2_f32_bf16 v14, v142, v142, v14
    v_dot2_f32_bf16 v15, v143, v143, v15
    v_mfma_f32_16x16x32_bf16 v[36:39], v[24:27], v[140:143], v[36:39]
    s_waitcnt lgkmcnt(0)
    v_mfma_f32_16x16x32_bf16 v[28:31], v[144:147], v[152:155], v[28:31]
    v_dot2_f32_bf16 v14, v152, v152, v14
    v_dot2_f32_bf16 v15, v153, v153, v15
    v_mfma_f32_16x16x32_bf16 v[32:35], v[148:151], v[152:155], v[32:35]
    v_dot2_f32_bf16 v14, v154, v154, v14
    v_dot2_f32_bf16 v15, v155, v155, v15
    v_mfma_f32_16x16x32_bf16 v[36:39], v[24:27], v[152:155], v[36:39]
    s_nop 3
    v_add_f32 v14, v14, v15
    s_nop 1
    v_mov_b32 v15, v14
    s_nop 1
    v_permlane32_swap_b32 v14, v15
    s_nop 1
    v_add_f32 v14, v14, v15
    s_nop 1
    v_mov_b32 v15, v14
    s_nop 1
    v_permlane16_swap_b32 v14, v15
    s_nop 1
    v_add_f32 v14, v14, v15
    v_mul_f32 v15, 0x3b000000, v36
    v_mul_f32 v14, 0x3b000000, v14
    v_fma_f32 v14, -v15, v15, v14
    v_add_f32 v14, 0x3727c5ac, v14
    v_rsq_f32 v14, v14
    s_nop 0
    v_mul_f32 v28, v28, v14
    v_mul_f32 v29, v29, v14
    v_mul_f32 v30, v30, v14
    v_mul_f32 v31, v31, v14
    v_mul_f32 v32, v32, v14
    v_mul_f32 v33, v33, v14
    v_mul_f32 v34, v34, v14
    v_mul_f32 v35, v35, v14
    v_cvt_pk_bf16_f32 v40, v28, v29
    v_cvt_pk_bf16_f32 v41, v30, v31
    v_cvt_pk_bf16_f32 v42, v32, v33
    v_cvt_pk_bf16_f32 v43, v34, v35
    ds_write_b64 v105, v[40:41]
    ds_write_b64 v105, v[42:43] offset:1024
    s_waitcnt lgkmcnt(0)
    s_barrier
    ds_read_b64_tr_b16 v[108:109], v106 offset:0
    ds_read_b64_tr_b16 v[110:111], v106 offset:128
    ds_read_b64_tr_b16 v[124:125], v106 offset:1024
    ds_read_b64_tr_b16 v[126:127], v106 offset:1152
    ds_read_b64_tr_b16 v[112:113], v106 offset:32768
    ds_read_b64_tr_b16 v[114:115], v106 offset:32896
    ds_read_b64_tr_b16 v[128:129], v106 offset:33792
    ds_read_b64_tr_b16 v[130:131], v106 offset:33920
    ds_read_b64_tr_b16 v[116:117], v107 offset:0
    ds_read_b64_tr_b16 v[118:119], v107 offset:128
    ds_read_b64_tr_b16 v[132:133], v107 offset:1024
    ds_read_b64_tr_b16 v[134:135], v107 offset:1152
    ds_read_b64_tr_b16 v[120:121], v107 offset:32768
    ds_read_b64_tr_b16 v[122:123], v107 offset:32896
    ds_read_b64_tr_b16 v[136:137], v107 offset:33792
    ds_read_b64_tr_b16 v[138:139], v107 offset:33920
    s_waitcnt lgkmcnt(12)
    v_mfma_f32_16x16x32_bf16 v[28:31], v[64:67], v[108:111], 0
    v_mfma_f32_16x16x32_bf16 v[32:35], v[80:83], v[124:127], 0
    v_mfma_f32_16x16x32_bf16 v[36:39], v[64:67], v[124:127], 0
    v_mfma_f32_16x16x32_bf16 v[44:47], v[80:83], v[108:111], 0
    s_waitcnt lgkmcnt(8)
    v_mfma_f32_16x16x32_bf16 v[28:31], v[68:71], v[112:115], v[28:31]
    v_mfma_f32_16x16x32_bf16 v[32:35], v[84:87], v[128:131], v[32:35]
    v_mfma_f32_16x16x32_bf16 v[36:39], v[68:71], v[128:131], v[36:39]
    v_mfma_f32_16x16x32_bf16 v[44:47], v[84:87], v[112:115], v[44:47]
    s_waitcnt lgkmcnt(4)
    v_mfma_f32_16x16x32_bf16 v[28:31], v[72:75], v[116:119], v[28:31]
    v_mfma_f32_16x16x32_bf16 v[32:35], v[88:91], v[132:135], v[32:35]
    v_mfma_f32_16x16x32_bf16 v[36:39], v[72:75], v[132:135], v[36:39]
    v_mfma_f32_16x16x32_bf16 v[44:47], v[88:91], v[116:119], v[44:47]
    s_waitcnt lgkmcnt(0)
    v_mfma_f32_16x16x32_bf16 v[28:31], v[76:79], v[120:123], v[28:31]
    v_mfma_f32_16x16x32_bf16 v[32:35], v[92:95], v[136:139], v[32:35]
    v_mfma_f32_16x16x32_bf16 v[36:39], v[76:79], v[136:139], v[36:39]
    v_mfma_f32_16x16x32_bf16 v[44:47], v[92:95], v[120:123], v[44:47]
    s_add_u32 s57, s56, 16384
    s_add_u32 s58, s56, 32768
    s_add_u32 s59, s56, 49152
    s_nop 7
    v_add_f32 v28, v28, v32
    v_sub_f32 v36, v36, v44
    v_add_f32 v29, v29, v33
    v_sub_f32 v37, v37, v45
    v_add_f32 v30, v30, v34
    v_sub_f32 v38, v38, v46
    v_add_f32 v31, v31, v35
    v_sub_f32 v39, v39, v47
    v_mul_f32 v32, v36, v100
    v_mul_f32 v44, v36, v96
    v_mul_f32 v33, v37, v101
    v_mul_f32 v45, v37, v97
    v_mul_f32 v34, v38, v102
    v_mul_f32 v46, v38, v98
    v_mul_f32 v35, v39, v103
    v_mul_f32 v47, v39, v99
    v_fma_f32 v32, v28, v96, -v32
    v_fma_f32 v44, v28, v100, v44
    v_fma_f32 v33, v29, v97, -v33
    v_fma_f32 v45, v29, v101, v45
    v_fma_f32 v34, v30, v98, -v34
    v_fma_f32 v46, v30, v102, v46
    v_fma_f32 v35, v31, v99, -v35
    v_fma_f32 v47, v31, v103, v47
    v_cvt_pk_bf16_f32 v48, v32, v44
    v_cvt_pk_bf16_f32 v49, v33, v45
    v_cvt_pk_bf16_f32 v50, v34, v46
    v_cvt_pk_bf16_f32 v51, v35, v47
    buffer_store_dword v48, v104, s[28:31], s56 offen sc1
    buffer_store_dword v49, v104, s[28:31], s57 offen sc1
    buffer_store_dword v50, v104, s[28:31], s58 offen sc1
    buffer_store_dword v51, v104, s[28:31], s59 offen sc1
L_r_done_401:
    s_endpgm
.globl c1_kernel
.p2align 8
.type c1_kernel,@function
c1_kernel:
    s_load_dwordx2 s[4:5], s[0:1], 88
    s_load_dwordx2 s[44:45], s[0:1], 88
    s_cmp_ge_u32 s2, 256
    s_cbranch_scc1 L_c_done_501
    s_bfe_u32 s62, s2, 0x10003
    s_lshr_b32 s63, s2, 4
    s_lshl_b32 s63, s63, 3
    s_and_b32 s2, s2, 7
    s_add_u32 s2, s2, s63
    v_lshrrev_b32 v1, 6, v0
    v_and_b32 v2, 63, v0
    v_readfirstlane_b32 s48, v1
    v_and_b32 v3, 15, v2
    v_lshrrev_b32 v4, 4, v2
    s_sub_u32 s46, 128, s2
    s_and_b32 s46, s46, 127
    s_cmp_ge_u32 s48, 4
    s_cselect_b32 s49, s46, s2
    s_lshl_b32 s49, s49, 4
    s_and_b32 s50, s48, 3
    s_lshl_b32 s50, s50, 2
    s_add_u32 s49, s49, s50
    s_lshl_b32 s49, s49, 10
    s_mul_i32 s51, s48, 4160
    v_lshlrev_b32 v5, 4, v2
    s_waitcnt lgkmcnt(0)
    s_mov_b32 s12, s44
    s_mov_b32 s13, s45
    s_mov_b32 s14, 2097152
    s_mov_b32 s15, 0x00020000
    s_add_u32 s52, s49, 0
    s_add_u32 m0, s51, 0
    s_nop 0
    buffer_load_dwordx4 v5, s[12:15], s52 offen lds
    s_add_u32 s52, s49, 1024
    s_add_u32 m0, s51, 1040
    s_nop 0
    buffer_load_dwordx4 v5, s[12:15], s52 offen lds
    s_add_u32 s52, s49, 2048
    s_add_u32 m0, s51, 2080
    s_nop 0
    buffer_load_dwordx4 v5, s[12:15], s52 offen lds
    s_add_u32 s52, s49, 3072
    s_add_u32 m0, s51, 3120
    s_nop 0
    buffer_load_dwordx4 v5, s[12:15], s52 offen lds
    s_add_u32 s8, s4, 14680064
    s_addc_u32 s9, s5, 0
    s_mov_b32 s10, 2097152
    s_mov_b32 s11, 0x00020000
    s_add_u32 s16, s44, 2097152
    s_addc_u32 s17, s45, 0
    s_mov_b32 s18, 2097152
    s_mov_b32 s19, 0x00020000
    s_add_u32 s20, s44, 4194304
    s_addc_u32 s21, s45, 0
    s_mov_b32 s22, 2097152
    s_mov_b32 s23, 0x00020000
    s_and_b32 s52, s2, 15
    s_lshl_b32 s52, s52, 7
    s_lshr_b32 s53, s2, 4
    s_add_u32 s52, s52, s53
    s_lshl_b32 s63, s62, 3
    s_add_u32 s63, s63, s48
    s_lshl_b32 s53, s63, 3
    s_add_u32 s52, s52, s53
    s_lshl_b32 s58, s52, 10
    s_add_u32 s59, s58, 8192
    s_mov_b32 s60, s58
    s_mov_b32 s61, s59
    v_lshlrev_b32 v6, 3, v2
    buffer_load_dwordx2 v[16:17], v6, s[8:11], s60 offen
    buffer_load_dwordx2 v[18:19], v6, s[8:11], s60 offen offset:512
    s_cmp_eq_u32 s2, 0
    s_cselect_b32 s54, 16, 15
    v_sub_u32 v7, s54, v3
    v_and_b32 v7, 15, v7
    s_cmp_ge_u32 s48, 4
    s_cselect_b64 vcc, -1, 0
    v_cndmask_b32 v7, v3, v7, vcc
    v_add_u32 v8, 0, v4
    v_mul_u32_u24 v8, v8, v7
    v_and_b32 v8, 15, v8
    v_cvt_f32_u32 v8, v8
    v_mul_f32 v8, 0x3d800000, v8
    v_cos_f32 v9, v8
    v_sin_f32 v10, v8
    s_nop 0
    v_cvt_pk_bf16_f32 v24, v9, v10
    v_add_u32 v8, 4, v4
    v_mul_u32_u24 v8, v8, v7
    v_and_b32 v8, 15, v8
    v_cvt_f32_u32 v8, v8
    v_mul_f32 v8, 0x3d800000, v8
    v_cos_f32 v9, v8
    v_sin_f32 v10, v8
    s_nop 0
    v_cvt_pk_bf16_f32 v25, v9, v10
    v_add_u32 v8, 8, v4
    v_mul_u32_u24 v8, v8, v7
    v_and_b32 v8, 15, v8
    v_cvt_f32_u32 v8, v8
    v_mul_f32 v8, 0x3d800000, v8
    v_cos_f32 v9, v8
    v_sin_f32 v10, v8
    s_nop 0
    v_cvt_pk_bf16_f32 v26, v9, v10
    v_add_u32 v8, 12, v4
    v_mul_u32_u24 v8, v8, v7
    v_and_b32 v8, 15, v8
    v_cvt_f32_u32 v8, v8
    v_mul_f32 v8, 0x3d800000, v8
    v_cos_f32 v9, v8
    v_sin_f32 v10, v8
    s_nop 0
    v_cvt_pk_bf16_f32 v27, v9, v10
    v_lshrrev_b32 v8, 2, v3
    v_lshlrev_b32 v8, 4, v8
    v_and_b32 v9, 3, v3
    v_add_u32 v8, v8, v9
    s_lshl_b32 s53, s48, 6
    v_add_u32 v8, s53, v8
    v_add_u32 v9, 0, v8
    v_sub_u32 v10, 512, v9
    v_and_b32 v10, 255, v10
    v_cndmask_b32 v9, v9, v10, vcc
    v_lshlrev_b32 v28, 2, v9
    v_add_u32 v9, 4, v8
    v_sub_u32 v10, 512, v9
    v_and_b32 v10, 255, v10
    v_cndmask_b32 v9, v9, v10, vcc
    v_lshlrev_b32 v29, 2, v9
    v_add_u32 v9, 8, v8
    v_sub_u32 v10, 512, v9
    v_and_b32 v10, 255, v10
    v_cndmask_b32 v9, v9, v10, vcc
    v_lshlrev_b32 v30, 2, v9
    v_add_u32 v9, 12, v8
    v_sub_u32 v10, 512, v9
    v_and_b32 v10, 255, v10
    v_cndmask_b32 v9, v9, v10, vcc
    v_lshlrev_b32 v31, 2, v9
    v_mul_u32_u24 v9, 1040, v4
    s_cmp_ge_u32 s48, 4
    s_cselect_b32 s55, 16640, 0
    v_add_u32 v9, s55, v9
    v_add_u32 v28, v28, v9
    v_add_u32 v29, v29, v9
    v_add_u32 v30, v30, v9
    v_add_u32 v31, v31, v9
    v_mov_b32 v32, 0
    v_mov_b32 v33, 0
    v_mov_b32 v34, 0
    v_mov_b32 v35, 0
    v_mov_b32 v36, 0
    v_mov_b32 v37, 0
    v_mov_b32 v38, 0
    v_mov_b32 v39, 0
    v_mov_b32 v40, 0
    v_mov_b32 v41, 0
    v_mov_b32 v42, 0
    v_mov_b32 v43, 0
    v_mov_b32 v44, 0
    v_mov_b32 v45, 0
    v_mov_b32 v46, 0
    v_mov_b32 v47, 0
    v_mul_u32_u24 v11, 2064, v3
    v_lshl_add_u32 v11, v4, 6, v11
    s_lshl_b32 s53, s48, 8
    s_add_u32 s53, s53, 33280
    v_add_u32 v11, s53, v11
    s_mul_i32 s53, s63, 2064
    s_add_u32 s53, s53, 33280
    v_lshlrev_b32 v12, 4, v2
    v_add_u32 v12, s53, v12
    s_waitcnt vmcnt(2)
    s_barrier
    ds_read_b32 v48, v28 offset:0
    ds_read_b32 v49, v28 offset:4160
    ds_read_b32 v50, v28 offset:8320
    ds_read_b32 v51, v28 offset:12480
    ds_read_b32 v52, v29 offset:0
    ds_read_b32 v53, v29 offset:4160
    ds_read_b32 v54, v29 offset:8320
    ds_read_b32 v55, v29 offset:12480
    ds_read_b32 v56, v30 offset:0
    ds_read_b32 v57, v30 offset:4160
    ds_read_b32 v58, v30 offset:8320
    ds_read_b32 v59, v30 offset:12480
    ds_read_b32 v60, v31 offset:0
    ds_read_b32 v61, v31 offset:4160
    ds_read_b32 v62, v31 offset:8320
    ds_read_b32 v63, v31 offset:12480
    s_waitcnt lgkmcnt(12)
    v_mfma_f32_16x16x32_bf16 v[32:35], v[48:51], v[24:27], v[32:35]
    s_waitcnt lgkmcnt(8)
    v_mfma_f32_16x16x32_bf16 v[36:39], v[52:55], v[24:27], v[36:39]
    s_waitcnt lgkmcnt(4)
    v_mfma_f32_16x16x32_bf16 v[40:43], v[56:59], v[24:27], v[40:43]
    s_waitcnt lgkmcnt(0)
    v_mfma_f32_16x16x32_bf16 v[44:47], v[60:63], v[24:27], v[44:47]
    v_cmp_gt_u32 s[56:57], 16, v0
    s_nop 7
    v_cndmask_b32 v32, v32, 0, s[56:57]
    s_nop 0
    ds_write_b128 v11, v[32:35] offset:0
    ds_write_b128 v11, v[36:39] offset:16
    ds_write_b128 v11, v[40:43] offset:32
    ds_write_b128 v11, v[44:47] offset:48
    s_waitcnt lgkmcnt(0)
    s_barrier
    ds_read_b128 v[48:51], v12
    ds_read_b128 v[52:55], v12 offset:1024
    s_waitcnt vmcnt(0)
    v_lshlrev_b32 v64, 16, v16
    v_and_b32 v65, 0xffff0000, v16
    v_lshlrev_b32 v66, 16, v17
    v_and_b32 v67, 0xffff0000, v17
    v_lshlrev_b32 v68, 16, v18
    v_and_b32 v69, 0xffff0000, v18
    v_lshlrev_b32 v70, 16, v19
    v_and_b32 v71, 0xffff0000, v19
    s_waitcnt lgkmcnt(0)
    v_add_f32 v64, v64, v48
    v_add_f32 v65, v65, v49
    v_add_f32 v66, v66, v50
    v_add_f32 v67, v67, v51
    v_add_f32 v68, v68, v52
    v_add_f32 v69, v69, v53
    v_add_f32 v70, v70, v54
    v_add_f32 v71, v71, v55
    v_cvt_pk_bf16_f32 v32, v64, v65
    v_cvt_pk_bf16_f32 v33, v66, v67
    v_cvt_pk_bf16_f32 v34, v68, v69
    v_cvt_pk_bf16_f32 v35, v70, v71
    buffer_store_dwordx2 v[32:33], v6, s[16:19], s58 offen sc1
    buffer_store_dwordx2 v[34:35], v6, s[16:19], s58 offen offset:512 sc1
    v_add_f32 v8, v64, v65
    v_mul_f32 v9, v64, v64
    v_fma_f32 v9, v65, v65, v9
    v_add_f32 v8, v8, v66
    v_fma_f32 v9, v66, v66, v9
    v_add_f32 v8, v8, v67
    v_fma_f32 v9, v67, v67, v9
    v_add_f32 v8, v8, v68
    v_fma_f32 v9, v68, v68, v9
    v_add_f32 v8, v8, v69
    v_fma_f32 v9, v69, v69, v9
    v_add_f32 v8, v8, v70
    v_fma_f32 v9, v70, v70, v9
    v_add_f32 v8, v8, v71
    v_fma_f32 v9, v71, v71, v9
    s_nop 1
    v_add_f32_dpp v8, v8, v8 row_ror:8 row_mask:0xf bank_mask:0xf
    v_add_f32_dpp v9, v9, v9 row_ror:8 row_mask:0xf bank_mask:0xf
    s_nop 0
    v_add_f32_dpp v8, v8, v8 row_ror:4 row_mask:0xf bank_mask:0xf
    v_add_f32_dpp v9, v9, v9 row_ror:4 row_mask:0xf bank_mask:0xf
    s_nop 0
    v_add_f32_dpp v8, v8, v8 row_ror:2 row_mask:0xf bank_mask:0xf
    v_add_f32_dpp v9, v9, v9 row_ror:2 row_mask:0xf bank_mask:0xf
    s_nop 0
    v_add_f32_dpp v8, v8, v8 row_ror:1 row_mask:0xf bank_mask:0xf
    v_add_f32_dpp v9, v9, v9 row_ror:1 row_mask:0xf bank_mask:0xf
    s_nop 0
    v_mov_b32 v40, v8
    v_mov_b32 v41, v9
    s_nop 1
    v_permlane16_swap_b32 v8, v40
    v_permlane16_swap_b32 v9, v41
    s_nop 1
    v_add_f32 v8, v8, v40
    v_add_f32 v9, v9, v41
    v_mov_b32 v40, v8
    v_mov_b32 v41, v9
    s_nop 1
    v_permlane32_swap_b32 v8, v40
    v_permlane32_swap_b32 v9, v41
    s_nop 1
    v_add_f32 v8, v8, v40
    v_add_f32 v9, v9, v41
    v_mul_f32 v8, 0x3b000000, v8
    v_mul_f32 v9, 0x3b000000, v9
    v_fma_f32 v9, -v8, v8, v9
    v_add_f32 v9, 0x3727c5ac, v9
    v_rsq_f32 v9, v9
    s_nop 0
    v_mul_f32 v8, v8, v9
    v_sub_f32 v8, 0, v8
    v_fma_f32 v64, v64, v9, v8
    v_fma_f32 v65, v65, v9, v8
    v_fma_f32 v66, v66, v9, v8
    v_fma_f32 v67, v67, v9, v8
    v_fma_f32 v68, v68, v9, v8
    v_fma_f32 v69, v69, v9, v8
    v_fma_f32 v70, v70, v9, v8
    v_fma_f32 v71, v71, v9, v8
    v_cvt_pk_bf16_f32 v48, v64, v65
    v_cvt_pk_bf16_f32 v49, v66, v67
    v_cvt_pk_bf16_f32 v50, v68, v69
    v_cvt_pk_bf16_f32 v51, v70, v71
    buffer_store_dwordx2 v[48:49], v6, s[20:23], s58 offen sc1
    buffer_store_dwordx2 v[50:51], v6, s[20:23], s58 offen offset:512 sc1
L_c_done_501:
    s_endpgm
.globl g21_kernel
.p2align 8
.type g21_kernel,@function
g21_kernel:
    s_load_dwordx2 s[4:5], s[0:1], 64
    s_load_dwordx2 s[6:7], s[0:1], 72
    s_load_dwordx2 s[44:45], s[0:1], 88
    s_cmp_ge_u32 s2, 256
    s_cbranch_scc1 L_g2_done_601
    s_and_b32 s46, s2, 7
    s_lshr_b32 s47, s2, 3
    s_lshl_b32 s49, s46, 2
    s_and_b32 s50, s47, 3
    s_add_u32 s49, s49, s50
    s_lshr_b32 s50, s47, 2
    v_lshrrev_b32 v1, 6, v0
    v_and_b32 v2, 63, v0
    v_readfirstlane_b32 s48, v1
    v_lshrrev_b32 v4, 4, v2
    s_lshl_b32 s51, s48, 2
    v_add_u32 v3, s51, v4
    v_and_b32 v5, 15, v3
    v_and_b32 v6, 15, v2
    v_xor_b32 v5, v5, v6
    v_mul_u32_u24 v3, 256, v3
    v_lshl_add_u32 v10, v5, 4, v3
    v_lshrrev_b32 v3, 3, v2
    s_lshl_b32 s51, s48, 3
    v_add_u32 v3, s51, v3
    v_bfe_u32 v5, v3, 1, 1
    v_lshlrev_b32 v5, 2, v5
    v_and_b32 v6, 7, v2
    v_xor_b32 v5, v5, v6
    v_lshlrev_b32 v3, 7, v3
    v_lshl_add_u32 v11, v5, 4, v3
    s_mul_i32 s52, s49, 229376
    s_lshl_b32 s53, s50, 7
    s_lshl_b32 s54, s48, 10
    s_mul_i32 s60, s50, 229376
    s_waitcnt lgkmcnt(0)
    s_add_u32 s8, s44, 6291456
    s_addc_u32 s9, s45, 0
    s_mov_b32 s10, 7340032
    s_mov_b32 s11, 0x00020000
    s_add_u32 s12, s44, 18874368
    s_addc_u32 s13, s45, 0
    s_mov_b32 s14, 1835008
    s_mov_b32 s15, 0x00020000
    s_add_u32 m0, s54, 0
    s_add_u32 s55, s52, 0
    buffer_load_dwordx4 v10, s[8:11], s55 offen lds
    s_add_u32 m0, s54, 8192
    s_add_u32 s55, s52, 8192
    buffer_load_dwordx4 v10, s[8:11], s55 offen lds
    s_add_u32 m0, s54, 16384
    s_add_u32 s55, s60, 0
    buffer_load_dwordx4 v11, s[12:15], s55 offen lds
    s_add_u32 m0, s54, 24576
    s_add_u32 s55, s60, 8192
    buffer_load_dwordx4 v11, s[12:15], s55 offen lds
    s_add_u32 m0, s54, 32768
    s_add_u32 s55, s52, 16384
    buffer_load_dwordx4 v10, s[8:11], s55 offen lds
    s_add_u32 s16, s44, 2097152
    s_addc_u32 s17, s45, 0
    s_mov_b32 s18, 2097152
    s_mov_b32 s19, 0x00020000
    s_add_u32 m0, s54, 40960
    s_add_u32 s55, s52, 24576
    buffer_load_dwordx4 v10, s[8:11], s55 offen lds
    s_mov_b32 s20, s6
    s_mov_b32 s21, s7
    s_mov_b32 s22, 2097152
    s_mov_b32 s23, 0x00020000
    s_and_b32 s56, s48, 1
    s_add_u32 m0, s54, 49152
    s_add_u32 s55, s60, 16384
    buffer_load_dwordx4 v11, s[12:15], s55 offen lds
    s_bfe_u32 s57, s48, 0x10001
    s_lshr_b32 s58, s48, 2
    v_and_b32 v3, 31, v2
    v_lshrrev_b32 v4, 5, v2
    s_add_u32 m0, s54, 57344
    s_add_u32 s55, s60, 24576
    buffer_load_dwordx4 v11, s[12:15], s55 offen lds
    s_lshl_b32 s51, s57, 5
    v_add_u32 v5, s51, v3
    v_and_b32 v6, 15, v5
    v_lshlrev_b32 v5, 8, v5
    s_lshl_b32 s51, s58, 3
    s_add_u32 m0, s54, 65536
    s_add_u32 s55, s52, 32768
    buffer_load_dwordx4 v10, s[8:11], s55 offen lds
    v_add_u32 v8, s51, v4
    v_add_u32 v7, 0, v8
    v_xor_b32 v7, v7, v6
    v_lshl_add_u32 v12, v7, 4, v5
    v_add_u32 v16, 65536, v12
    s_add_u32 m0, s54, 73728
    s_add_u32 s55, s52, 40960
    buffer_load_dwordx4 v10, s[8:11], s55 offen lds
    v_add_u32 v20, 131072, v12
    v_add_u32 v7, 2, v8
    v_xor_b32 v7, v7, v6
    v_lshl_add_u32 v13, v7, 4, v5
    s_add_u32 m0, s54, 81920
    s_add_u32 s55, s60, 32768
    buffer_load_dwordx4 v11, s[12:15], s55 offen lds
    v_add_u32 v17, 65536, v13
    v_add_u32 v21, 131072, v13
    v_add_u32 v7, 4, v8
    v_xor_b32 v7, v7, v6
    v_lshl_add_u32 v14, v7, 4, v5
    s_add_u32 m0, s54, 90112
    s_add_u32 s55, s60, 40960
    buffer_load_dwordx4 v11, s[12:15], s55 offen lds
    v_add_u32 v18, 65536, v14
    v_add_u32 v22, 131072, v14
    v_add_u32 v7, 6, v8
    v_xor_b32 v7, v7, v6
    v_lshl_add_u32 v15, v7, 4, v5
    s_add_u32 m0, s54, 98304
    s_add_u32 s55, s52, 49152
    buffer_load_dwordx4 v10, s[8:11], s55 offen lds
    v_add_u32 v19, 65536, v15
    v_add_u32 v23, 131072, v15
    v_and_b32 v5, 15, v2
    v_lshrrev_b32 v5, 2, v5
    s_add_u32 m0, s54, 106496
    s_add_u32 s55, s52, 57344
    buffer_load_dwordx4 v10, s[8:11], s55 offen lds
    v_lshl_add_u32 v6, v4, 3, v5
    s_lshl_b32 s51, s58, 6
    v_add_u32 v6, s51, v6
    v_lshlrev_b32 v6, 7, v6
    v_bfe_u32 v7, v5, 1, 1
    s_add_u32 m0, s54, 114688
    s_add_u32 s55, s60, 49152
    buffer_load_dwordx4 v11, s[12:15], s55 offen lds
    v_xor_b32 v7, s56, v7
    v_lshlrev_b32 v7, 2, v7
    v_bfe_u32 v8, v2, 4, 1
    v_lshl_add_u32 v7, v8, 1, v7
    s_add_u32 m0, s54, 122880
    s_add_u32 s55, s60, 57344
    buffer_load_dwordx4 v11, s[12:15], s55 offen lds
    v_bfe_u32 v8, v2, 1, 1
    v_add_u32 v7, v7, v8
    v_lshl_add_u32 v6, v7, 4, v6
    v_and_b32 v8, 1, v2
    v_lshl_add_u32 v6, v8, 3, v6
    s_add_u32 m0, s54, 131072
    s_add_u32 s55, s52, 65536
    buffer_load_dwordx4 v10, s[8:11], s55 offen lds
    v_add_u32 v28, 16384, v6
    v_add_u32 v29, 65536, v28
    v_add_u32 v30, 131072, v28
    v_lshrrev_b32 v5, 3, v2
    s_lshl_b32 s51, s48, 3
    s_add_u32 m0, s54, 139264
    s_add_u32 s55, s52, 73728
    buffer_load_dwordx4 v10, s[8:11], s55 offen lds
    v_add_u32 v5, s51, v5
    v_and_b32 v6, 7, v2
    v_lshlrev_b32 v6, 4, v6
    s_lshl_b32 s51, s49, 6
    s_add_u32 m0, s54, 147456
    s_add_u32 s55, s60, 65536
    buffer_load_dwordx4 v11, s[12:15], s55 offen lds
    v_add_u32 v7, s51, v5
    v_lshl_add_u32 v80, v7, 10, v6
    s_and_b32 s51, s49, 1
    s_lshl_b32 s51, s51, 6
    v_add_u32 v7, s51, v5
    s_add_u32 m0, s54, 155648
    s_add_u32 s55, s60, 73728
    buffer_load_dwordx4 v11, s[12:15], s55 offen lds
    v_lshlrev_b32 v7, 4, v7
    s_lshr_b32 s51, s49, 1
    v_add_u32 v7, s51, v7
    v_lshl_add_u32 v81, v7, 10, v6
    s_mov_b32 s59, s53
    s_waitcnt vmcnt(16)
    s_barrier
    ds_read_b64_tr_b16 v[32:33], v28 offset:0
    ds_read_b64_tr_b16 v[34:35], v28 offset:512
    ds_read_b128 v[36:39], v12 offset:0
    ds_read_b64_tr_b16 v[40:41], v28 offset:2048
    ds_read_b64_tr_b16 v[42:43], v28 offset:2560
    ds_read_b128 v[44:47], v13 offset:0
    ds_read_b64_tr_b16 v[48:49], v28 offset:4096
    ds_read_b64_tr_b16 v[50:51], v28 offset:4608
    ds_read_b128 v[52:55], v14 offset:0
    ds_read_b64_tr_b16 v[56:57], v28 offset:6144
    ds_read_b64_tr_b16 v[58:59], v28 offset:6656
    ds_read_b128 v[60:63], v15 offset:0
    s_waitcnt lgkmcnt(9)
    v_mfma_f32_32x32x16_bf16 v[64:79], v[32:35], v[36:39], 0
    s_waitcnt lgkmcnt(6)
    v_mfma_f32_32x32x16_bf16 v[64:79], v[40:43], v[44:47], v[64:79]
    s_waitcnt lgkmcnt(3)
    v_mfma_f32_32x32x16_bf16 v[64:79], v[48:51], v[52:55], v[64:79]
    s_waitcnt lgkmcnt(0)
    v_mfma_f32_32x32x16_bf16 v[64:79], v[56:59], v[60:63], v[64:79]
    s_waitcnt vmcnt(12)
    s_barrier
    ds_read_b64_tr_b16 v[32:33], v28 offset:32768
    ds_read_b64_tr_b16 v[34:35], v28 offset:33280
    ds_read_b128 v[36:39], v12 offset:32768
    ds_read_b64_tr_b16 v[40:41], v28 offset:34816
    ds_read_b64_tr_b16 v[42:43], v28 offset:35328
    ds_read_b128 v[44:47], v13 offset:32768
    ds_read_b64_tr_b16 v[48:49], v28 offset:36864
    ds_read_b64_tr_b16 v[50:51], v28 offset:37376
    ds_read_b128 v[52:55], v14 offset:32768
    ds_read_b64_tr_b16 v[56:57], v28 offset:38912
    ds_read_b64_tr_b16 v[58:59], v28 offset:39424
    ds_read_b128 v[60:63], v15 offset:32768
    s_add_u32 m0, s54, 0
    s_add_u32 s55, s52, 81920
    buffer_load_dwordx4 v10, s[8:11], s55 offen lds
    s_waitcnt lgkmcnt(9)
    v_mfma_f32_32x32x16_bf16 v[64:79], v[32:35], v[36:39], v[64:79]
    s_add_u32 m0, s54, 8192
    s_add_u32 s55, s52, 90112
    buffer_load_dwordx4 v10, s[8:11], s55 offen lds
    s_waitcnt lgkmcnt(6)
    v_mfma_f32_32x32x16_bf16 v[64:79], v[40:43], v[44:47], v[64:79]
    s_add_u32 m0, s54, 16384
    s_add_u32 s55, s60, 81920
    buffer_load_dwordx4 v11, s[12:15], s55 offen lds
    s_waitcnt lgkmcnt(3)
    v_mfma_f32_32x32x16_bf16 v[64:79], v[48:51], v[52:55], v[64:79]
    s_add_u32 m0, s54, 24576
    s_add_u32 s55, s60, 90112
    buffer_load_dwordx4 v11, s[12:15], s55 offen lds
    s_waitcnt lgkmcnt(0)
    v_mfma_f32_32x32x16_bf16 v[64:79], v[56:59], v[60:63], v[64:79]
    s_waitcnt vmcnt(12)
    s_barrier
    ds_read_b64_tr_b16 v[32:33], v29 offset:0
    ds_read_b64_tr_b16 v[34:35], v29 offset:512
    ds_read_b128 v[36:39], v16 offset:0
    ds_read_b64_tr_b16 v[40:41], v29 offset:2048
    ds_read_b64_tr_b16 v[42:43], v29 offset:2560
    ds_read_b128 v[44:47], v17 offset:0
    ds_read_b64_tr_b16 v[48:49], v29 offset:4096
    ds_read_b64_tr_b16 v[50:51], v29 offset:4608
    ds_read_b128 v[52:55], v18 offset:0
    ds_read_b64_tr_b16 v[56:57], v29 offset:6144
    ds_read_b64_tr_b16 v[58:59], v29 offset:6656
    ds_read_b128 v[60:63], v19 offset:0
    s_add_u32 m0, s54, 32768
    s_add_u32 s55, s52, 98304
    buffer_load_dwordx4 v10, s[8:11], s55 offen lds
    s_waitcnt lgkmcnt(9)
    v_mfma_f32_32x32x16_bf16 v[64:79], v[32:35], v[36:39], v[64:79]
    s_add_u32 m0, s54, 40960
    s_add_u32 s55, s52, 106496
    buffer_load_dwordx4 v10, s[8:11], s55 offen lds
    s_waitcnt lgkmcnt(6)
    v_mfma_f32_32x32x16_bf16 v[64:79], v[40:43], v[44:47], v[64:79]
    s_add_u32 m0, s54, 49152
    s_add_u32 s55, s60, 98304
    buffer_load_dwordx4 v11, s[12:15], s55 offen lds
    s_waitcnt lgkmcnt(3)
    v_mfma_f32_32x32x16_bf16 v[64:79], v[48:51], v[52:55], v[64:79]
    s_add_u32 m0, s54, 57344
    s_add_u32 s55, s60, 106496
    buffer_load_dwordx4 v11, s[12:15], s55 offen lds
    s_waitcnt lgkmcnt(0)
    v_mfma_f32_32x32x16_bf16 v[64:79], v[56:59], v[60:63], v[64:79]
    s_waitcnt vmcnt(12)
    s_barrier
    ds_read_b64_tr_b16 v[32:33], v29 offset:32768
    ds_read_b64_tr_b16 v[34:35], v29 offset:33280
    ds_read_b128 v[36:39], v16 offset:32768
    ds_read_b64_tr_b16 v[40:41], v29 offset:34816
    ds_read_b64_tr_b16 v[42:43], v29 offset:35328
    ds_read_b128 v[44:47], v17 offset:32768
    ds_read_b64_tr_b16 v[48:49], v29 offset:36864
    ds_read_b64_tr_b16 v[50:51], v29 offset:37376
    ds_read_b128 v[52:55], v18 offset:32768
    ds_read_b64_tr_b16 v[56:57], v29 offset:38912
    ds_read_b64_tr_b16 v[58:59], v29 offset:39424
    ds_read_b128 v[60:63], v19 offset:32768
    s_add_u32 m0, s54, 65536
    s_add_u32 s55, s52, 114688
    buffer_load_dwordx4 v10, s[8:11], s55 offen lds
    s_waitcnt lgkmcnt(9)
    v_mfma_f32_32x32x16_bf16 v[64:79], v[32:35], v[36:39], v[64:79]
    s_add_u32 m0, s54, 73728
    s_add_u32 s55, s52, 122880
    buffer_load_dwordx4 v10, s[8:11], s55 offen lds
    s_waitcnt lgkmcnt(6)
    v_mfma_f32_32x32x16_bf16 v[64:79], v[40:43], v[44:47], v[64:79]
    s_add_u32 m0, s54, 81920
    s_add_u32 s55, s60, 114688
    buffer_load_dwordx4 v11, s[12:15], s55 offen lds
    s_waitcnt lgkmcnt(3)
    v_mfma_f32_32x32x16_bf16 v[64:79], v[48:51], v[52:55], v[64:79]
    s_add_u32 m0, s54, 90112
    s_add_u32 s55, s60, 122880
    buffer_load_dwordx4 v11, s[12:15], s55 offen lds
    s_waitcnt lgkmcnt(0)
    v_mfma_f32_32x32x16_bf16 v[64:79], v[56:59], v[60:63], v[64:79]
    s_waitcnt vmcnt(12)
    s_barrier
    ds_read_b64_tr_b16 v[32:33], v30 offset:0
    ds_read_b64_tr_b16 v[34:35], v30 offset:512
    ds_read_b128 v[36:39], v20 offset:0
    ds_read_b64_tr_b16 v[40:41], v30 offset:2048
    ds_read_b64_tr_b16 v[42:43], v30 offset:2560
    ds_read_b128 v[44:47], v21 offset:0
    ds_read_b64_tr_b16 v[48:49], v30 offset:4096
    ds_read_b64_tr_b16 v[50:51], v30 offset:4608
    ds_read_b128 v[52:55], v22 offset:0
    ds_read_b64_tr_b16 v[56:57], v30 offset:6144
    ds_read_b64_tr_b16 v[58:59], v30 offset:6656
    ds_read_b128 v[60:63], v23 offset:0
    s_add_u32 m0, s54, 98304
    s_add_u32 s55, s52, 131072
    buffer_load_dwordx4 v10, s[8:11], s55 offen lds
    s_waitcnt lgkmcnt(9)
    v_mfma_f32_32x32x16_bf16 v[64:79], v[32:35], v[36:39], v[64:79]
    s_add_u32 m0, s54, 106496
    s_add_u32 s55, s52, 139264
    buffer_load_dwordx4 v10, s[8:11], s55 offen lds
    s_waitcnt lgkmcnt(6)
    v_mfma_f32_32x32x16_bf16 v[64:79], v[40:43], v[44:47], v[64:79]
    s_add_u32 m0, s54, 114688
    s_add_u32 s55, s60, 131072
    buffer_load_dwordx4 v11, s[12:15], s55 offen lds
    s_waitcnt lgkmcnt(3)
    v_mfma_f32_32x32x16_bf16 v[64:79], v[48:51], v[52:55], v[64:79]
    s_add_u32 m0, s54, 122880
    s_add_u32 s55, s60, 139264
    buffer_load_dwordx4 v11, s[12:15], s55 offen lds
    s_waitcnt lgkmcnt(0)
    v_mfma_f32_32x32x16_bf16 v[64:79], v[56:59], v[60:63], v[64:79]
    s_waitcnt vmcnt(12)
    s_barrier
    ds_read_b64_tr_b16 v[32:33], v28 offset:0
    ds_read_b64_tr_b16 v[34:35], v28 offset:512
    ds_read_b128 v[36:39], v12 offset:0
    ds_read_b64_tr_b16 v[40:41], v28 offset:2048
    ds_read_b64_tr_b16 v[42:43], v28 offset:2560
    ds_read_b128 v[44:47], v13 offset:0
    ds_read_b64_tr_b16 v[48:49], v28 offset:4096
    ds_read_b64_tr_b16 v[50:51], v28 offset:4608
    ds_read_b128 v[52:55], v14 offset:0
    ds_read_b64_tr_b16 v[56:57], v28 offset:6144
    ds_read_b64_tr_b16 v[58:59], v28 offset:6656
    ds_read_b128 v[60:63], v15 offset:0
    s_add_u32 m0, s54, 131072
    s_add_u32 s55, s52, 147456
    buffer_load_dwordx4 v10, s[8:11], s55 offen lds
    s_waitcnt lgkmcnt(9)
    v_mfma_f32_32x32x16_bf16 v[64:79], v[32:35], v[36:39], v[64:79]
    s_add_u32 m0, s54, 139264
    s_add_u32 s55, s52, 155648
    buffer_load_dwordx4 v10, s[8:11], s55 offen lds
    s_waitcnt lgkmcnt(6)
    v_mfma_f32_32x32x16_bf16 v[64:79], v[40:43], v[44:47], v[64:79]
    s_add_u32 m0, s54, 147456
    s_add_u32 s55, s60, 147456
    buffer_load_dwordx4 v11, s[12:15], s55 offen lds
    s_waitcnt lgkmcnt(3)
    v_mfma_f32_32x32x16_bf16 v[64:79], v[48:51], v[52:55], v[64:79]
    s_add_u32 m0, s54, 155648
    s_add_u32 s55, s60, 155648
    buffer_load_dwordx4 v11, s[12:15], s55 offen lds
    s_waitcnt lgkmcnt(0)
    v_mfma_f32_32x32x16_bf16 v[64:79], v[56:59], v[60:63], v[64:79]
    s_waitcnt vmcnt(12)
    s_barrier
    ds_read_b64_tr_b16 v[32:33], v28 offset:32768
    ds_read_b64_tr_b16 v[34:35], v28 offset:33280
    ds_read_b128 v[36:39], v12 offset:32768
    ds_read_b64_tr_b16 v[40:41], v28 offset:34816
    ds_read_b64_tr_b16 v[42:43], v28 offset:35328
    ds_read_b128 v[44:47], v13 offset:32768
    ds_read_b64_tr_b16 v[48:49], v28 offset:36864
    ds_read_b64_tr_b16 v[50:51], v28 offset:37376
    ds_read_b128 v[52:55], v14 offset:32768
    ds_read_b64_tr_b16 v[56:57], v28 offset:38912
    ds_read_b64_tr_b16 v[58:59], v28 offset:39424
    ds_read_b128 v[60:63], v15 offset:32768
    s_add_u32 m0, s54, 0
    s_add_u32 s55, s52, 163840
    buffer_load_dwordx4 v10, s[8:11], s55 offen lds
    s_waitcnt lgkmcnt(9)
    v_mfma_f32_32x32x16_bf16 v[64:79], v[32:35], v[36:39], v[64:79]
    s_add_u32 m0, s54, 8192
    s_add_u32 s55, s52, 172032
    buffer_load_dwordx4 v10, s[8:11], s55 offen lds
    s_waitcnt lgkmcnt(6)
    v_mfma_f32_32x32x16_bf16 v[64:79], v[40:43], v[44:47], v[64:79]
    s_add_u32 m0, s54, 16384
    s_add_u32 s55, s60, 163840
    buffer_load_dwordx4 v11, s[12:15], s55 offen lds
    s_waitcnt lgkmcnt(3)
    v_mfma_f32_32x32x16_bf16 v[64:79], v[48:51], v[52:55], v[64:79]
    s_add_u32 m0, s54, 24576
    s_add_u32 s55, s60, 172032
    buffer_load_dwordx4 v11, s[12:15], s55 offen lds
    s_waitcnt lgkmcnt(0)
    v_mfma_f32_32x32x16_bf16 v[64:79], v[56:59], v[60:63], v[64:79]
    s_waitcnt vmcnt(12)
    s_barrier
    ds_read_b64_tr_b16 v[32:33], v29 offset:0
    ds_read_b64_tr_b16 v[34:35], v29 offset:512
    ds_read_b128 v[36:39], v16 offset:0
    ds_read_b64_tr_b16 v[40:41], v29 offset:2048
    ds_read_b64_tr_b16 v[42:43], v29 offset:2560
    ds_read_b128 v[44:47], v17 offset:0
    ds_read_b64_tr_b16 v[48:49], v29 offset:4096
    ds_read_b64_tr_b16 v[50:51], v29 offset:4608
    ds_read_b128 v[52:55], v18 offset:0
    ds_read_b64_tr_b16 v[56:57], v29 offset:6144
    ds_read_b64_tr_b16 v[58:59], v29 offset:6656
    ds_read_b128 v[60:63], v19 offset:0
    s_add_u32 m0, s54, 32768
    s_add_u32 s55, s52, 180224
    buffer_load_dwordx4 v10, s[8:11], s55 offen lds
    s_waitcnt lgkmcnt(9)
    v_mfma_f32_32x32x16_bf16 v[64:79], v[32:35], v[36:39], v[64:79]
    s_add_u32 m0, s54, 40960
    s_add_u32 s55, s52, 188416
    buffer_load_dwordx4 v10, s[8:11], s55 offen lds
    s_waitcnt lgkmcnt(6)
    v_mfma_f32_32x32x16_bf16 v[64:79], v[40:43], v[44:47], v[64:79]
    s_add_u32 m0, s54, 49152
    s_add_u32 s55, s60, 180224
    buffer_load_dwordx4 v11, s[12:15], s55 offen lds
    s_waitcnt lgkmcnt(3)
    v_mfma_f32_32x32x16_bf16 v[64:79], v[48:51], v[52:55], v[64:79]
    s_add_u32 m0, s54, 57344
    s_add_u32 s55, s60, 188416
    buffer_load_dwordx4 v11, s[12:15], s55 offen lds
    s_waitcnt lgkmcnt(0)
    v_mfma_f32_32x32x16_bf16 v[64:79], v[56:59], v[60:63], v[64:79]
    s_waitcnt vmcnt(12)
    s_barrier
    ds_read_b64_tr_b16 v[32:33], v29 offset:32768
    ds_read_b64_tr_b16 v[34:35], v29 offset:33280
    ds_read_b128 v[36:39], v16 offset:32768
    ds_read_b64_tr_b16 v[40:41], v29 offset:34816
    ds_read_b64_tr_b16 v[42:43], v29 offset:35328
    ds_read_b128 v[44:47], v17 offset:32768
    ds_read_b64_tr_b16 v[48:49], v29 offset:36864
    ds_read_b64_tr_b16 v[50:51], v29 offset:37376
    ds_read_b128 v[52:55], v18 offset:32768
    ds_read_b64_tr_b16 v[56:57], v29 offset:38912
    ds_read_b64_tr_b16 v[58:59], v29 offset:39424
    ds_read_b128 v[60:63], v19 offset:32768
    s_add_u32 m0, s54, 65536
    s_add_u32 s55, s52, 196608
    buffer_load_dwordx4 v10, s[8:11], s55 offen lds
    s_waitcnt lgkmcnt(9)
    v_mfma_f32_32x32x16_bf16 v[64:79], v[32:35], v[36:39], v[64:79]
    s_add_u32 m0, s54, 73728
    s_add_u32 s55, s52, 204800
    buffer_load_dwordx4 v10, s[8:11], s55 offen lds
    s_waitcnt lgkmcnt(6)
    v_mfma_f32_32x32x16_bf16 v[64:79], v[40:43], v[44:47], v[64:79]
    s_add_u32 m0, s54, 81920
    s_add_u32 s55, s60, 196608
    buffer_load_dwordx4 v11, s[12:15], s55 offen lds
    s_waitcnt lgkmcnt(3)
    v_mfma_f32_32x32x16_bf16 v[64:79], v[48:51], v[52:55], v[64:79]
    s_add_u32 m0, s54, 90112
    s_add_u32 s55, s60, 204800
    buffer_load_dwordx4 v11, s[12:15], s55 offen lds
    s_waitcnt lgkmcnt(0)
    v_mfma_f32_32x32x16_bf16 v[64:79], v[56:59], v[60:63], v[64:79]
    s_waitcnt vmcnt(12)
    s_barrier
    ds_read_b64_tr_b16 v[32:33], v30 offset:0
    ds_read_b64_tr_b16 v[34:35], v30 offset:512
    ds_read_b128 v[36:39], v20 offset:0
    ds_read_b64_tr_b16 v[40:41], v30 offset:2048
    ds_read_b64_tr_b16 v[42:43], v30 offset:2560
    ds_read_b128 v[44:47], v21 offset:0
    ds_read_b64_tr_b16 v[48:49], v30 offset:4096
    ds_read_b64_tr_b16 v[50:51], v30 offset:4608
    ds_read_b128 v[52:55], v22 offset:0
    ds_read_b64_tr_b16 v[56:57], v30 offset:6144
    ds_read_b64_tr_b16 v[58:59], v30 offset:6656
    ds_read_b128 v[60:63], v23 offset:0
    s_add_u32 m0, s54, 98304
    s_add_u32 s55, s52, 212992
    buffer_load_dwordx4 v10, s[8:11], s55 offen lds
    s_waitcnt lgkmcnt(9)
    v_mfma_f32_32x32x16_bf16 v[64:79], v[32:35], v[36:39], v[64:79]
    s_add_u32 m0, s54, 106496
    s_add_u32 s55, s52, 221184
    buffer_load_dwordx4 v10, s[8:11], s55 offen lds
    s_waitcnt lgkmcnt(6)
    v_mfma_f32_32x32x16_bf16 v[64:79], v[40:43], v[44:47], v[64:79]
    s_add_u32 m0, s54, 114688
    s_add_u32 s55, s60, 212992
    buffer_load_dwordx4 v11, s[12:15], s55 offen lds
    s_waitcnt lgkmcnt(3)
    v_mfma_f32_32x32x16_bf16 v[64:79], v[48:51], v[52:55], v[64:79]
    s_add_u32 m0, s54, 122880
    s_add_u32 s55, s60, 221184
    buffer_load_dwordx4 v11, s[12:15], s55 offen lds
    s_waitcnt lgkmcnt(0)
    v_mfma_f32_32x32x16_bf16 v[64:79], v[56:59], v[60:63], v[64:79]
    s_waitcnt vmcnt(12)
    s_barrier
    ds_read_b64_tr_b16 v[32:33], v28 offset:0
    ds_read_b64_tr_b16 v[34:35], v28 offset:512
    ds_read_b128 v[36:39], v12 offset:0
    ds_read_b64_tr_b16 v[40:41], v28 offset:2048
    ds_read_b64_tr_b16 v[42:43], v28 offset:2560
    ds_read_b128 v[44:47], v13 offset:0
    ds_read_b64_tr_b16 v[48:49], v28 offset:4096
    ds_read_b64_tr_b16 v[50:51], v28 offset:4608
    ds_read_b128 v[52:55], v14 offset:0
    ds_read_b64_tr_b16 v[56:57], v28 offset:6144
    ds_read_b64_tr_b16 v[58:59], v28 offset:6656
    ds_read_b128 v[60:63], v15 offset:0
    s_waitcnt lgkmcnt(9)
    v_mfma_f32_32x32x16_bf16 v[64:79], v[32:35], v[36:39], v[64:79]
    s_waitcnt lgkmcnt(6)
    v_mfma_f32_32x32x16_bf16 v[64:79], v[40:43], v[44:47], v[64:79]
    s_waitcnt lgkmcnt(3)
    v_mfma_f32_32x32x16_bf16 v[64:79], v[48:51], v[52:55], v[64:79]
    s_waitcnt lgkmcnt(0)
    v_mfma_f32_32x32x16_bf16 v[64:79], v[56:59], v[60:63], v[64:79]
    s_waitcnt vmcnt(8)
    s_barrier
    buffer_load_dwordx4 v[24:27], v80, s[16:19], s53 offen
    ds_read_b64_tr_b16 v[32:33], v28 offset:32768
    ds_read_b64_tr_b16 v[34:35], v28 offset:33280
    ds_read_b128 v[36:39], v12 offset:32768
    ds_read_b64_tr_b16 v[40:41], v28 offset:34816
    ds_read_b64_tr_b16 v[42:43], v28 offset:35328
    ds_read_b128 v[44:47], v13 offset:32768
    ds_read_b64_tr_b16 v[48:49], v28 offset:36864
    ds_read_b64_tr_b16 v[50:51], v28 offset:37376
    ds_read_b128 v[52:55], v14 offset:32768
    ds_read_b64_tr_b16 v[56:57], v28 offset:38912
    ds_read_b64_tr_b16 v[58:59], v28 offset:39424
    ds_read_b128 v[60:63], v15 offset:32768
    s_waitcnt lgkmcnt(9)
    v_mfma_f32_32x32x16_bf16 v[64:79], v[32:35], v[36:39], v[64:79]
    s_waitcnt lgkmcnt(6)
    v_mfma_f32_32x32x16_bf16 v[64:79], v[40:43], v[44:47], v[64:79]
    s_waitcnt lgkmcnt(3)
    v_mfma_f32_32x32x16_bf16 v[64:79], v[48:51], v[52:55], v[64:79]
    s_waitcnt lgkmcnt(0)
    v_mfma_f32_32x32x16_bf16 v[64:79], v[56:59], v[60:63], v[64:79]
    s_waitcnt vmcnt(5)
    s_barrier
    ds_read_b64_tr_b16 v[32:33], v29 offset:0
    ds_read_b64_tr_b16 v[34:35], v29 offset:512
    ds_read_b128 v[36:39], v16 offset:0
    ds_read_b64_tr_b16 v[40:41], v29 offset:2048
    ds_read_b64_tr_b16 v[42:43], v29 offset:2560
    ds_read_b128 v[44:47], v17 offset:0
    ds_read_b64_tr_b16 v[48:49], v29 offset:4096
    ds_read_b64_tr_b16 v[50:51], v29 offset:4608
    ds_read_b128 v[52:55], v18 offset:0
    ds_read_b64_tr_b16 v[56:57], v29 offset:6144
    ds_read_b64_tr_b16 v[58:59], v29 offset:6656
    ds_read_b128 v[60:63], v19 offset:0
    s_waitcnt lgkmcnt(9)
    v_mfma_f32_32x32x16_bf16 v[64:79], v[32:35], v[36:39], v[64:79]
    s_waitcnt lgkmcnt(6)
    v_mfma_f32_32x32x16_bf16 v[64:79], v[40:43], v[44:47], v[64:79]
    s_waitcnt lgkmcnt(3)
    v_mfma_f32_32x32x16_bf16 v[64:79], v[48:51], v[52:55], v[64:79]
    s_waitcnt lgkmcnt(0)
    v_mfma_f32_32x32x16_bf16 v[64:79], v[56:59], v[60:63], v[64:79]
    s_waitcnt vmcnt(0)
    s_barrier
    ds_read_b64_tr_b16 v[32:33], v29 offset:32768
    ds_read_b64_tr_b16 v[34:35], v29 offset:33280
    ds_read_b128 v[36:39], v16 offset:32768
    ds_read_b64_tr_b16 v[40:41], v29 offset:34816
    ds_read_b64_tr_b16 v[42:43], v29 offset:35328
    ds_read_b128 v[44:47], v17 offset:32768
    ds_read_b64_tr_b16 v[48:49], v29 offset:36864
    ds_read_b64_tr_b16 v[50:51], v29 offset:37376
    ds_read_b128 v[52:55], v18 offset:32768
    ds_read_b64_tr_b16 v[56:57], v29 offset:38912
    ds_read_b64_tr_b16 v[58:59], v29 offset:39424
    ds_read_b128 v[60:63], v19 offset:32768
    s_waitcnt lgkmcnt(9)
    v_mfma_f32_32x32x16_bf16 v[64:79], v[32:35], v[36:39], v[64:79]
    s_waitcnt lgkmcnt(6)
    v_mfma_f32_32x32x16_bf16 v[64:79], v[40:43], v[44:47], v[64:79]
    s_waitcnt lgkmcnt(3)
    v_mfma_f32_32x32x16_bf16 v[64:79], v[48:51], v[52:55], v[64:79]
    s_waitcnt lgkmcnt(0)
    v_mfma_f32_32x32x16_bf16 v[64:79], v[56:59], v[60:63], v[64:79]
    v_and_b32 v3, 31, v2
    s_lshl_b32 s51, s57, 5
    v_add_u32 v3, s51, v3
    v_mul_u32_u24 v3, 272, v3
    v_lshrrev_b32 v4, 5, v2
    v_lshl_add_u32 v3, v4, 4, v3
    s_mul_i32 s51, s58, 17408
    s_lshl_b32 s55, s56, 7
    s_add_u32 s51, s51, s55
    s_add_u32 s51, s51, 0
    v_add_u32 v3, s51, v3
    s_nop 7
    ds_write_b128 v3, v[64:67] offset:0
    ds_write_b128 v3, v[68:71] offset:32
    ds_write_b128 v3, v[72:75] offset:64
    ds_write_b128 v3, v[76:79] offset:96
    v_lshrrev_b32 v5, 3, v2
    s_lshl_b32 s51, s48, 3
    v_add_u32 v5, s51, v5
    v_mul_u32_u24 v5, 272, v5
    v_and_b32 v6, 7, v2
    v_lshl_add_u32 v5, v6, 5, v5
    v_add_u32 v5, 0, v5
    s_waitcnt lgkmcnt(0)
    s_barrier
    ds_read_b128 v[40:43], v5
    ds_read_b128 v[44:47], v5 offset:16
    ds_read_b128 v[48:51], v5 offset:17408
    ds_read_b128 v[52:55], v5 offset:17424
    s_waitcnt vmcnt(0)
    v_lshlrev_b32 v56, 16, v24
    v_and_b32 v57, 0xffff0000, v24
    v_lshlrev_b32 v58, 16, v25
    v_and_b32 v59, 0xffff0000, v25
    v_lshlrev_b32 v60, 16, v26
    v_and_b32 v61, 0xffff0000, v26
    v_lshlrev_b32 v62, 16, v27
    v_and_b32 v63, 0xffff0000, v27
    s_waitcnt lgkmcnt(0)
    v_add_f32 v40, v40, v48
    v_add_f32 v41, v41, v49
    v_add_f32 v42, v42, v50
    v_add_f32 v43, v43, v51
    v_add_f32 v44, v44, v52
    v_add_f32 v45, v45, v53
    v_add_f32 v46, v46, v54
    v_add_f32 v47, v47, v55
    v_add_f32 v40, v40, v56
    v_add_f32 v41, v41, v57
    v_add_f32 v42, v42, v58
    v_add_f32 v43, v43, v59
    v_add_f32 v44, v44, v60
    v_add_f32 v45, v45, v61
    v_add_f32 v46, v46, v62
    v_add_f32 v47, v47, v63
    v_cvt_pk_bf16_f32 v32, v40, v41
    v_cvt_pk_bf16_f32 v33, v42, v43
    v_cvt_pk_bf16_f32 v34, v44, v45
    v_cvt_pk_bf16_f32 v35, v46, v47
    buffer_store_dwordx4 v[32:35], v81, s[20:23], s59 offen sc1
L_g2_done_601:
    s_endpgm
.section .rodata,"a"
.p2align 6
.p2align 6
.amdhsa_kernel r0_kernel
  .amdhsa_next_free_vgpr 160
  .amdhsa_next_free_sgpr 102
  .amdhsa_accum_offset 160
  .amdhsa_group_segment_fixed_size 0
  .amdhsa_kernarg_size 96
  .amdhsa_user_sgpr_count 2
  .amdhsa_user_sgpr_kernarg_segment_ptr 1
  .amdhsa_system_sgpr_workgroup_id_x 1
.end_amdhsa_kernel
.p2align 6
.amdhsa_kernel c0_kernel
  .amdhsa_next_free_vgpr 80
  .amdhsa_next_free_sgpr 102
  .amdhsa_accum_offset 80
  .amdhsa_group_segment_fixed_size 0
  .amdhsa_kernarg_size 96
  .amdhsa_user_sgpr_count 2
  .amdhsa_user_sgpr_kernarg_segment_ptr 1
  .amdhsa_system_sgpr_workgroup_id_x 1
.end_amdhsa_kernel
.p2align 6
.amdhsa_kernel g1_kernel
  .amdhsa_next_free_vgpr 128
  .amdhsa_next_free_sgpr 102
  .amdhsa_accum_offset 128
  .amdhsa_group_segment_fixed_size 0
  .amdhsa_kernarg_size 96
  .amdhsa_user_sgpr_count 2
  .amdhsa_user_sgpr_kernarg_segment_ptr 1
  .amdhsa_system_sgpr_workgroup_id_x 1
.end_amdhsa_kernel
.p2align 6
.amdhsa_kernel g20_kernel
  .amdhsa_next_free_vgpr 96
  .amdhsa_next_free_sgpr 102
  .amdhsa_accum_offset 96
  .amdhsa_group_segment_fixed_size 0
  .amdhsa_kernarg_size 96
  .amdhsa_user_sgpr_count 2
  .amdhsa_user_sgpr_kernarg_segment_ptr 1
  .amdhsa_system_sgpr_workgroup_id_x 1
.end_amdhsa_kernel
.p2align 6
.amdhsa_kernel r1_kernel
  .amdhsa_next_free_vgpr 160
  .amdhsa_next_free_sgpr 102
  .amdhsa_accum_offset 160
  .amdhsa_group_segment_fixed_size 0
  .amdhsa_kernarg_size 96
  .amdhsa_user_sgpr_count 2
  .amdhsa_user_sgpr_kernarg_segment_ptr 1
  .amdhsa_system_sgpr_workgroup_id_x 1
.end_amdhsa_kernel
.p2align 6
.amdhsa_kernel c1_kernel
  .amdhsa_next_free_vgpr 80
  .amdhsa_next_free_sgpr 102
  .amdhsa_accum_offset 80
  .amdhsa_group_segment_fixed_size 0
  .amdhsa_kernarg_size 96
  .amdhsa_user_sgpr_count 2
  .amdhsa_user_sgpr_kernarg_segment_ptr 1
  .amdhsa_system_sgpr_workgroup_id_x 1
.end_amdhsa_kernel
.p2align 6
.amdhsa_kernel g21_kernel
  .amdhsa_next_free_vgpr 96
  .amdhsa_next_free_sgpr 102
  .amdhsa_accum_offset 96
  .amdhsa_group_segment_fixed_size 0
  .amdhsa_kernarg_size 96
  .amdhsa_user_sgpr_count 2
  .amdhsa_user_sgpr_kernarg_segment_ptr 1
  .amdhsa_system_sgpr_workgroup_id_x 1
.end_amdhsa_kernel
```
